```python
import torch

def _softmax(x, axis=-1):
    return torch.softmax(x, dim=axis)
def _gelu(x):
    return torch.nn.functional.gelu(x, approximate="tanh")
def _silu(x):
    return torch.nn.functional.silu(x)
def _sigmoid(x):
    return torch.sigmoid(x)
def _layernorm(x, axis=-1, eps=1e-5):
    m = x.mean(dim=axis, keepdim=True)
    v = x.var(dim=axis, keepdim=True, unbiased=False)
    return (x - m) / torch.sqrt(v + eps)
def _scatter_add(tgt, idx, src, axis=0):
    return tgt.clone().index_add_(axis, idx, src)
def _segment_sum(src, seg, n):
    out = torch.zeros((n,) + src.shape[1:], dtype=src.dtype)
    return out.index_add_(0, seg, src)
def _pad(x, pw):
    flat = tuple(v for pair in reversed(pw) for v in pair)
    return torch.nn.functional.pad(x, flat)

kernel_name = 'standalone__cheap_equivariant_egnn__graph'

def setup_inputs():

    _w = (lambda a: (lambda t: t.to(torch.bfloat16) if t.is_floating_point() else t)(torch.as_tensor(a)))
    N, deg, D, De = 25000, 32, 64, max(4, 1)
    E = N * deg
    return {
        "h": _w((lambda *s: torch.randn(*s, dtype=torch.bfloat16) * 0.2)(N, D)),
        "pos": _w((lambda *s: torch.randn(*s, dtype=torch.bfloat16) * 0.8)(N, 3)),
        "e_attr": _w((lambda *s: torch.randn(*s, dtype=torch.bfloat16) * 0.8)(E, De)),
        "src": _w((lambda lo, hi, *s: torch.randint(lo, hi, s))(0, N, E).to(torch.int64)),
        "dst": _w((lambda lo, hi, *s: torch.randint(lo, hi, s))(0, N, E).to(torch.int64)),
        "w_e": _w(0.1 * (lambda *s: torch.randn(*s, dtype=torch.bfloat16) * 0.8)(2 * D + 1 + De, D)),
        "w_x": _w(0.1 * (lambda *s: torch.randn(*s, dtype=torch.bfloat16) * 0.2)(D, 1)),
        "w_h": _w(0.1 * (lambda *s: torch.randn(*s, dtype=torch.bfloat16) * 0.2)(2 * D, D)),
    }

def reference(h, pos, e_attr, src, dst, w_e, w_x, w_h):
    N, D = h.shape[0], h.shape[1]
    diff = pos[dst] - pos[src]
    dist2 = torch.sum(diff * diff, axis=-1, keepdims=True)
    e_in = torch.concatenate([h[dst], h[src], dist2, e_attr], axis=-1)
    m_ij = _silu(e_in @ w_e)
    coord_scale = m_ij @ w_x
    pos_new = pos + _segment_sum(diff * coord_scale, dst, N)
    m_i = _segment_sum(m_ij, dst, N)
    h_new = h + _silu(torch.concatenate([h, m_i], axis=-1) @ w_h)
    return h_new, pos_new
```

```asm
; @launch kernel=egnn_part_kernel grid=(253,1,1) block=(832,1,1) lds=42496
; @launch kernel=egnn_main_kernel grid=(256,1,1) block=(768,1,1) lds=163200
.amdgcn_target "amdgcn-amd-amdhsa--gfx950"
.text
.globl egnn_part_kernel
.p2align 8
.type egnn_part_kernel,@function
egnn_part_kernel:
    s_cmp_ge_u32 s2, 253
    s_cbranch_scc1 K1_EXIT
    s_cmp_ge_u32 s2, 250
    s_cbranch_scc1 K1_WEIGHTS
    s_load_dwordx4 s[4:7], s[0:1], 8
    s_load_dwordx4 s[8:11], s[0:1], 24
    s_load_dwordx2 s[12:13], s[0:1], 80
    s_load_dwordx2 s[14:15], s[0:1], 0

    v_lshlrev_b32 v1, 2, v0
    v_mov_b32 v2, 0
    ds_write_b32 v1, v2
    v_cmp_gt_u32 vcc, 800, v0
    s_mov_b64 s[38:39], vcc
    v_lshlrev_b32 v1, 4, v0
    v_lshlrev_b32 v2, 5, v0
    v_mov_b32 v3, 1
    v_readfirstlane_b32 s40, v0
    s_mul_i32 s36, s2, 12800
    s_mul_i32 s37, s2, 25600
    s_waitcnt lgkmcnt(0)
    s_mov_b32 s16, s4
    s_mov_b32 s17, s5
    s_mov_b32 s18, 150000
    s_mov_b32 s19, 0x00020000
    s_mov_b32 s20, s6
    s_mov_b32 s21, s7
    s_mov_b32 s22, 6400000
    s_mov_b32 s23, 0x00020000
    s_mov_b32 s24, s8
    s_mov_b32 s25, s9
    s_mov_b32 s26, 3200000
    s_mov_b32 s27, 0x00020000
    s_mov_b32 s28, s10
    s_mov_b32 s29, s11
    s_mov_b32 s30, 3200000
    s_mov_b32 s31, 0x00020000
    s_mov_b32 s32, s12
    s_mov_b32 s33, s13
    s_mov_b32 s34, 0x1200000
    s_mov_b32 s35, 0x00020000
    s_mov_b64 exec, s[38:39]

    buffer_load_dwordx4 v[4:7], v1, s[28:31], s36 offen nt
    s_barrier
    buffer_load_dwordx4 v[8:11], v1, s[24:27], s36 offen nt
    buffer_load_dwordx4 v[12:15], v2, s[20:23], s37 offen nt
    buffer_load_dwordx4 v[16:19], v2, s[20:23], s37 offen offset:16 nt

    v_subrev_u32 v30, 128, v0
    v_mul_u32_u24 v31, 6, v30
    s_mul_i32 s41, s2, 600
    v_cmp_gt_u32 vcc, 100, v30
    s_mov_b64 s[44:45], vcc
    s_mov_b64 exec, vcc
    buffer_load_ushort v32, v31, s[16:19], s41 offen
    buffer_load_ushort v33, v31, s[16:19], s41 offen offset:2
    buffer_load_ushort v34, v31, s[16:19], s41 offen offset:4

    s_mov_b64 exec, s[38:39]
    s_waitcnt vmcnt(6)

    v_mul_u32_u24 v44, 85599, v4
    v_lshrrev_b32 v44, 22, v44
    v_lshrrev_b32 v68, 1, v44
    v_lshlrev_b32 v44, 2, v44
    ds_add_rtn_u32 v48, v44, v3
    v_mul_u32_u24 v68, 98, v68
    v_sub_u32 v68, v4, v68

    v_mul_u32_u24 v45, 85599, v5
    v_lshrrev_b32 v45, 22, v45
    v_lshrrev_b32 v69, 1, v45
    v_lshlrev_b32 v45, 2, v45
    ds_add_rtn_u32 v49, v45, v3
    v_mul_u32_u24 v69, 98, v69
    v_sub_u32 v69, v5, v69

    v_mul_u32_u24 v46, 85599, v6
    v_lshrrev_b32 v46, 22, v46
    v_lshrrev_b32 v70, 1, v46
    v_lshlrev_b32 v46, 2, v46
    ds_add_rtn_u32 v50, v46, v3
    v_mul_u32_u24 v70, 98, v70
    v_sub_u32 v70, v6, v70

    v_mul_u32_u24 v47, 85599, v7
    v_lshrrev_b32 v47, 22, v47
    v_lshrrev_b32 v71, 1, v47
    v_lshlrev_b32 v47, 2, v47
    ds_add_rtn_u32 v51, v47, v3
    v_mul_u32_u24 v71, 98, v71
    v_sub_u32 v71, v7, v71

    s_waitcnt lgkmcnt(0)
    s_barrier

    s_cmp_ge_u32 s40, 64
    s_cbranch_scc1 K1_NOSCAN
    v_lshlrev_b32 v80, 5, v0
    ds_read_b128 v[84:87], v80
    ds_read_b128 v[88:91], v80 offset:16
    s_waitcnt lgkmcnt(0)
    v_add_u32 v92, v84, v85
    v_add_u32 v93, v92, v86
    v_add_u32 v94, v93, v87
    v_add_u32 v95, v94, v88
    v_add_u32 v96, v95, v89
    v_add_u32 v97, v96, v90
    v_add_u32 v98, v97, v91
    v_mov_b32 v99, v98
    s_nop 1
    v_add_u32_dpp v99, v99, v99 row_shr:1 row_mask:0xf bank_mask:0xf
    s_nop 1
    v_add_u32_dpp v99, v99, v99 row_shr:2 row_mask:0xf bank_mask:0xf
    s_nop 1
    v_add_u32_dpp v99, v99, v99 row_shr:4 row_mask:0xf bank_mask:0xf
    s_nop 1
    v_add_u32_dpp v99, v99, v99 row_shr:8 row_mask:0xf bank_mask:0xf
    s_nop 1
    v_add_u32_dpp v99, v99, v99 row_bcast:15 row_mask:0xa bank_mask:0xf
    s_nop 1
    v_add_u32_dpp v99, v99, v99 row_bcast:31 row_mask:0xc bank_mask:0xf
    v_sub_u32 v100, v99, v98
    v_add_u32 v101, v100, v84
    v_add_u32 v102, v100, v92
    v_add_u32 v103, v100, v93
    v_add_u32 v104, v100, v94
    v_add_u32 v105, v100, v95
    v_add_u32 v106, v100, v96
    v_add_u32 v107, v100, v97
    ds_write_b128 v80, v[100:103]
    ds_write_b128 v80, v[104:107] offset:16
    v_lshl_or_b32 v108, v101, 16, v100
    v_lshl_or_b32 v109, v103, 16, v102
    v_lshl_or_b32 v110, v105, 16, v104
    v_lshl_or_b32 v111, v107, 16, v106
    s_mul_i32 s41, s2, 1040
    s_add_u32 s41, s41, 16777216
    buffer_store_dwordx4 v[108:111], v1, s[32:35], s41 offen
    v_mov_b32 v112, 209718400
    v_mov_b32 v113, v112
    v_mov_b32 v114, v112
    v_mov_b32 v115, v112
    s_mov_b64 exec, 1
    buffer_store_dwordx4 v[112:115], v1, s[32:35], s41 offen offset:1024
    s_mov_b64 exec, -1
    s_waitcnt lgkmcnt(0)
K1_NOSCAN:
    s_barrier

    ds_read_b32 v80, v44
    ds_read_b32 v81, v45
    ds_read_b32 v82, v46
    ds_read_b32 v83, v47
    s_waitcnt vmcnt(0)
    v_lshl_or_b32 v68, v68, 20, v8
    v_lshl_or_b32 v69, v69, 20, v9
    v_lshl_or_b32 v70, v70, 20, v10
    v_lshl_or_b32 v71, v71, 20, v11
    s_waitcnt lgkmcnt(0)
    v_add_u32 v80, v80, v48
    v_mul_u32_u24 v80, 12, v80
    v_add_u32 v80, 4096, v80
    ds_write2_b32 v80, v12, v13 offset0:0 offset1:1
    ds_write_b32 v80, v68 offset:8

    v_add_u32 v81, v81, v49
    v_mul_u32_u24 v81, 12, v81
    v_add_u32 v81, 4096, v81
    ds_write2_b32 v81, v14, v15 offset0:0 offset1:1
    ds_write_b32 v81, v69 offset:8

    v_add_u32 v82, v82, v50
    v_mul_u32_u24 v82, 12, v82
    v_add_u32 v82, 4096, v82
    ds_write2_b32 v82, v16, v17 offset0:0 offset1:1
    ds_write_b32 v82, v70 offset:8

    v_add_u32 v83, v83, v51
    v_mul_u32_u24 v83, 12, v83
    v_add_u32 v83, 4096, v83
    ds_write2_b32 v83, v18, v19 offset0:0 offset1:1
    ds_write_b32 v83, v71 offset:8

    s_mov_b64 exec, s[44:45]
    v_lshlrev_b32 v32, 16, v32
    v_lshlrev_b32 v33, 16, v33
    v_lshlrev_b32 v34, 16, v34
    v_mov_b32 v35, 0
    v_lshlrev_b32 v31, 4, v30
    s_mul_i32 s41, s2, 1600
    s_add_u32 s41, s41, 10485760
    buffer_store_dwordx4 v[32:35], v31, s[32:35], s41 offen

    s_mov_b64 exec, s[38:39]
    s_waitcnt lgkmcnt(0)
    s_barrier

    ds_read_b128 v[4:7], v1 offset:4096
    ds_read_b128 v[8:11], v1 offset:16896
    ds_read_b128 v[12:15], v1 offset:29696
    s_mul_i32 s42, s2, 38400
    s_add_u32 s43, s42, 12800
    s_add_u32 s44, s42, 25600
    s_waitcnt lgkmcnt(2)
    buffer_store_dwordx4 v[4:7], v1, s[32:35], s42 offen sc0 sc1
    s_waitcnt lgkmcnt(1)
    buffer_store_dwordx4 v[8:11], v1, s[32:35], s43 offen sc0 sc1
    s_waitcnt lgkmcnt(0)
    buffer_store_dwordx4 v[12:15], v1, s[32:35], s44 offen sc0 sc1

K1_EXIT:
    s_endpgm

K1_WEIGHTS:
    s_load_dwordx2 s[4:5], s[0:1], 40
    s_load_dwordx2 s[6:7], s[0:1], 56
    s_load_dwordx2 s[12:13], s[0:1], 80
    v_lshrrev_b32 v1, 6, v0
    s_nop 0
    v_readfirstlane_b32 s40, v1
    s_sub_u32 s41, s2, 250
    s_mul_i32 s41, s41, 13
    s_add_u32 s40, s40, s41
    s_cmp_gt_u32 s40, 32
    s_cbranch_scc1 K1_EXIT
    v_and_b32 v1, 63, v0
    v_and_b32 v2, 31, v1
    v_lshrrev_b32 v3, 5, v1
    s_waitcnt lgkmcnt(0)
    s_mov_b32 s32, s12
    s_mov_b32 s33, s13
    s_mov_b32 s34, 0x1200000
    s_mov_b32 s35, 0x00020000
    s_cmp_lt_u32 s40, 16
    s_cselect_b32 s16, s4, s6
    s_cselect_b32 s17, s5, s7
    s_mov_b32 s47, 16384
    s_cselect_b32 s18, 17024, s47
    s_mov_b32 s19, 0x00020000
    s_cmp_eq_u32 s40, 32
    s_cbranch_scc1 K1_WXC
    s_cmp_lt_u32 s40, 16
    s_cbranch_scc0 K1_WH
    s_cmp_lt_u32 s40, 8
    s_cselect_b32 s42, 64, 0
    s_lshr_b32 s43, s40, 2
    s_and_b32 s43, s43, 1
    s_and_b32 s44, s40, 3
    s_branch K1_WGO
K1_WH:
    s_sub_u32 s45, s40, 16
    s_lshr_b32 s43, s45, 3
    s_and_b32 s44, s45, 3
    s_and_b32 s45, s45, 4
    s_lshl_b32 s42, s45, 4
K1_WGO:
    s_lshl_b32 s44, s44, 3
    s_add_u32 s42, s42, s44
    s_lshl_b32 s42, s42, 7
    s_lshl_b32 s43, s43, 6
    s_add_u32 s42, s42, s43
    v_lshlrev_b32 v4, 12, v3
    v_lshl_add_u32 v4, v2, 1, v4

    buffer_load_ushort v8, v4, s[16:19], s42 offen offset:0
    buffer_load_ushort v9, v4, s[16:19], s42 offen offset:128
    buffer_load_ushort v10, v4, s[16:19], s42 offen offset:256
    buffer_load_ushort v11, v4, s[16:19], s42 offen offset:384
    buffer_load_ushort v12, v4, s[16:19], s42 offen offset:512
    buffer_load_ushort v13, v4, s[16:19], s42 offen offset:640
    buffer_load_ushort v14, v4, s[16:19], s42 offen offset:768
    buffer_load_ushort v15, v4, s[16:19], s42 offen offset:896
    s_lshl_b32 s46, s40, 10
    s_add_u32 s46, s46, 17825792
    v_lshlrev_b32 v5, 4, v1
    s_cmp_lt_u32 s40, 8
    s_cselect_b32 s47, 0xbfb8aa3b, 1.0
    s_waitcnt vmcnt(0)

    v_lshlrev_b32 v8, 16, v8
    v_mul_f32 v8, s47, v8
    v_lshlrev_b32 v9, 16, v9
    v_mul_f32 v9, s47, v9
    v_lshlrev_b32 v10, 16, v10
    v_mul_f32 v10, s47, v10
    v_lshlrev_b32 v11, 16, v11
    v_mul_f32 v11, s47, v11
    v_lshlrev_b32 v12, 16, v12
    v_mul_f32 v12, s47, v12
    v_lshlrev_b32 v13, 16, v13
    v_mul_f32 v13, s47, v13
    v_lshlrev_b32 v14, 16, v14
    v_mul_f32 v14, s47, v14
    v_lshlrev_b32 v15, 16, v15
    v_mul_f32 v15, s47, v15
    v_cvt_pk_bf16_f32 v16, v8, v9
    v_cvt_pk_bf16_f32 v17, v10, v11
    v_cvt_pk_bf16_f32 v18, v12, v13
    v_cvt_pk_bf16_f32 v19, v14, v15
    buffer_store_dwordx4 v[16:19], v5, s[32:35], s46 offen
    s_endpgm
K1_WXC:
    s_mov_b32 s16, s4
    s_mov_b32 s17, s5
    s_mov_b32 s18, 17024
    s_mov_b32 s42, 16384
    v_lshlrev_b32 v4, 1, v2

    buffer_load_ushort v8, v4, s[16:19], s42 offen offset:0
    buffer_load_ushort v9, v4, s[16:19], s42 offen offset:128
    buffer_load_ushort v10, v4, s[16:19], s42 offen offset:256
    buffer_load_ushort v11, v4, s[16:19], s42 offen offset:384
    buffer_load_ushort v12, v4, s[16:19], s42 offen offset:512
    buffer_load_ushort v13, v4, s[16:19], s42 offen offset:64
    buffer_load_ushort v14, v4, s[16:19], s42 offen offset:192
    buffer_load_ushort v15, v4, s[16:19], s42 offen offset:320
    buffer_load_ushort v16, v4, s[16:19], s42 offen offset:448
    buffer_load_ushort v17, v4, s[16:19], s42 offen offset:576
    v_cmp_eq_u32 vcc, 0, v3
    v_lshlrev_b32 v5, 3, v1
    s_mov_b32 s46, 17858560
    s_waitcnt vmcnt(0)

    v_lshlrev_b32 v8, 16, v8
    v_mul_f32 v8, 0xbfb8aa3b, v8
    v_lshlrev_b32 v9, 16, v9
    v_mul_f32 v9, 0xbfb8aa3b, v9
    v_lshlrev_b32 v10, 16, v10
    v_mul_f32 v10, 0xbfb8aa3b, v10
    v_lshlrev_b32 v11, 16, v11
    v_mul_f32 v11, 0xbfb8aa3b, v11
    v_lshlrev_b32 v12, 16, v12
    v_mul_f32 v12, 0xbfb8aa3b, v12
    v_lshlrev_b32 v13, 16, v13
    v_mul_f32 v13, 0xbfb8aa3b, v13
    v_lshlrev_b32 v14, 16, v14
    v_mul_f32 v14, 0xbfb8aa3b, v14
    v_lshlrev_b32 v15, 16, v15
    v_mul_f32 v15, 0xbfb8aa3b, v15
    v_lshlrev_b32 v16, 16, v16
    v_mul_f32 v16, 0xbfb8aa3b, v16
    v_lshlrev_b32 v17, 16, v17
    v_mul_f32 v17, 0xbfb8aa3b, v17
    v_cvt_pk_bf16_f32 v20, v9, v10
    v_cvt_pk_bf16_f32 v21, v11, v12
    v_cvt_pk_bf16_f32 v26, v8, 0
    v_lshlrev_b32 v26, 16, v26
    v_sub_f32 v27, v8, v26
    v_cvt_pk_bf16_f32 v8, v26, v27
    v_cndmask_b32 v22, v8, v20, vcc
    v_cndmask_b32 v23, 0, v21, vcc

    v_cvt_pk_bf16_f32 v20, v14, v15
    v_cvt_pk_bf16_f32 v21, v16, v17
    v_cvt_pk_bf16_f32 v26, v13, 0
    v_lshlrev_b32 v26, 16, v26
    v_sub_f32 v27, v13, v26
    v_cvt_pk_bf16_f32 v13, v26, v27
    v_cndmask_b32 v24, v13, v20, vcc
    v_cndmask_b32 v25, 0, v21, vcc

    buffer_store_dwordx2 v[22:23], v5, s[32:35], s46 offen
    buffer_store_dwordx2 v[24:25], v5, s[32:35], s46 offen offset:512
    s_endpgm

.globl egnn_main_kernel
.p2align 8
.type egnn_main_kernel,@function
egnn_main_kernel:
    s_cmp_ge_u32 s2, 256
    s_cbranch_scc1 K2_EXIT
    s_load_dwordx4 s[4:7], s[0:1], 0
    s_load_dwordx2 s[8:9], s[0:1], 48
    s_load_dwordx2 s[10:11], s[0:1], 64
    s_load_dwordx2 s[12:13], s[0:1], 80
    s_and_b32 s3, s2, 7
    s_lshl_b32 s3, s3, 5
    s_lshr_b32 s14, s2, 3
    s_add_u32 s3, s3, s14
    s_mul_i32 s33, s3, 98
    v_lshrrev_b32 v1, 6, v0
    s_nop 0
    v_readfirstlane_b32 s32, v1
    s_mov_b32 s48, -1
    s_mov_b32 s49, 0
    s_mov_b32 s50, 0
    s_mov_b32 s51, -1
    s_mov_b32 s52, 0x11111111
    s_mov_b32 s53, 0x11111111
    s_not_b64 s[54:55], s[52:53]
    s_mov_b32 s46, 0xbfb8aa3b
    s_mov_b32 s47, 0xbfb8aa3b
    s_mov_b32 s62, 208
    s_mov_b32 s63, 288
    s_lshl_b32 s43, s32, 12
    s_add_u32 s43, s43, 114048
    s_mov_b32 s56, 0
    s_mov_b32 s57, 36
    s_waitcnt lgkmcnt(0)
    s_mov_b32 s16, s4
    s_or_b32 s17, s5, 8388608
    s_mov_b32 s18, 25000
    s_mov_b32 s19, 0x00020000
    s_mov_b32 s20, s12
    s_mov_b32 s21, s13
    s_mov_b32 s22, 0x1200000
    s_mov_b32 s23, 0x00020000
    s_add_u32 s24, s12, 10485760
    s_addc_u32 s25, s13, 0
    s_or_b32 s25, s25, 1048576
    s_mov_b32 s26, 25000
    s_mov_b32 s27, 0x00020000
    s_mov_b32 s28, s8
    s_mov_b32 s29, s9
    s_mov_b32 s30, 128
    s_mov_b32 s31, 0x00020000
    s_mov_b32 s9, 0

K2_ROUND:
    v_mbcnt_lo_u32_b32 v133, -1, 0
    v_mbcnt_hi_u32_b32 v133, -1, v133
    s_lshl_b32 s59, s32, 6
    v_add_u32 v132, s59, v133
    v_lshrrev_b32 v150, 2, v132
    v_and_b32 v134, 3, v132
    v_mul_u32_u24 v151, 1040, v150
    s_lshl_b32 s14, s3, 2
    s_add_u32 s14, s14, 16777216
    s_add_u32 s59, s14, 199680
    v_cmp_gt_u32 vcc, 232, v132
    s_mov_b64 s[44:45], vcc
    buffer_load_dwordx2 v[162:163], v151, s[20:23], s14 offen
    s_mov_b64 exec, s[44:45]
    buffer_load_dwordx2 v[164:165], v151, s[20:23], s59 offen
    s_mov_b64 exec, -1
    v_mul_u32_u24 v136, 3200, v150
    v_mov_b32 v44, -1
    v_mov_b32 v45, -1
    v_mov_b32 v46, -1
    v_mov_b32 v47, -1
    v_lshlrev_b32 v48, 4, v132
    ds_write_b128 v48, v[44:47] offset:1536
    v_cmp_gt_u32 vcc, 96, v132
    s_mov_b64 exec, vcc
    ds_write_b128 v48, v[44:47] offset:13824
    s_mov_b64 exec, -1
    v_mov_b32 v44, 0
    v_mov_b32 v45, 0
    v_mov_b32 v46, 0
    v_mov_b32 v47, 0
    v_cmp_gt_u32 vcc, 36, v132
    s_mov_b64 exec, vcc
    ds_write_b128 v48, v[44:47] offset:0
    s_mov_b64 exec, -1
    s_mov_b32 s39, 0
    s_cmp_lg_u32 s56, 0
    s_cbranch_scc1 K2_NOINIT
    s_cmp_lg_u32 s57, 36
    s_cbranch_scc1 K2_NOINIT
    s_mov_b32 s39, 1
    v_add_u32 v49, 57984, v48

    ds_write_b128 v49, v[44:47] offset:0
    ds_write_b128 v49, v[44:47] offset:12288
    ds_write_b128 v49, v[44:47] offset:24576
    ds_write_b128 v49, v[44:47] offset:36864
    v_cmp_gt_u32 vcc, 426, v132
    s_mov_b64 exec, vcc
    ds_write_b128 v49, v[44:47] offset:49152
    s_mov_b64 exec, -1
    v_lshrrev_b32 v54, 1, v132
    v_and_b32 v55, 1, v132
    v_lshrrev_b32 v56, 2, v54
    v_and_b32 v57, 3, v54
    v_lshlrev_b32 v57, 4, v57
    v_mov_b32 v58, 0x3f80
    v_mov_b32 v59, 0
    v_lshlrev_b64 v[58:59], v57, v[58:59]
    v_cmp_eq_u32 vcc, v56, v55
    s_nop 1
    v_cndmask_b32 v58, 0, v58, vcc
    v_cndmask_b32 v59, 0, v59, vcc
    v_lshlrev_b32 v60, 3, v132
    v_cmp_gt_u32 vcc, 16, v132
    s_mov_b64 exec, vcc
    ds_write_b64 v60, v[58:59] offset:1152
    s_mov_b64 exec, -1
K2_NOINIT:

    v_and_b32 v152, 7, v133
    v_lshrrev_b32 v153, 4, v133
    v_xor_b32 v152, v152, v153
    v_lshlrev_b32 v143, 4, v152
    v_lshlrev_b32 v147, 4, v152
    v_xor_b32 v145, 64, v143
    v_xor_b32 v149, 64, v143
    v_and_b32 v152, 31, v133
    v_lshrrev_b32 v153, 5, v133
    v_bfe_u32 v154, v152, 1, 3
    v_lshlrev_b32 v153, 2, v153
    v_xor_b32 v153, v153, v154
    v_lshlrev_b32 v153, 4, v153
    v_lshl_add_u32 v153, v152, 7, v153
    v_add_u32 v158, s43, v153
    v_xor_b32 v159, 16, v158
    v_xor_b32 v160, 32, v158
    v_xor_b32 v161, 48, v158

    v_mov_b32 v139, 1
    s_waitcnt lgkmcnt(0)
    s_barrier
    s_waitcnt vmcnt(0)

    v_and_b32 v135, 0xffff, v162
    v_and_b32 v162, 0xffff, v163
    v_and_b32 v137, 0xffff, v164
    v_and_b32 v164, 0xffff, v165
    v_add_u32 v138, 614400, v136
    v_add_u32 v136, v136, v135
    v_add_u32 v138, v138, v137
    v_sub_u32 v135, v162, v135
    v_sub_u32 v137, v164, v137
    v_cndmask_b32 v137, 0, v137, s[44:45]

    v_subrev_u32 v162, s56, v135
    v_min_i32 v162, s57, v162
    v_sub_u32 v162, v162, v134
    v_add3_u32 v164, v136, v134, s56
    v_mul_u32_u24 v164, 12, v164

    v_cmp_lt_i32 s[64:65], 0, v162
    v_cmp_lt_i32 s[66:67], 4, v162
    v_cmp_lt_i32 s[68:69], 8, v162
    v_cmp_lt_i32 s[70:71], 12, v162
    v_cmp_lt_i32 s[72:73], 16, v162
    v_cmp_lt_i32 s[74:75], 20, v162
    v_cmp_lt_i32 s[76:77], 24, v162
    v_cmp_lt_i32 s[78:79], 28, v162
    v_cmp_lt_i32 s[80:81], 32, v162
    v_subrev_u32 v162, s56, v137
    v_min_i32 v162, s57, v162
    v_sub_u32 v162, v162, v134
    v_add3_u32 v165, v138, v134, s56
    v_mul_u32_u24 v165, 12, v165

    v_cmp_lt_i32 s[82:83], 0, v162
    v_cmp_lt_i32 s[84:85], 4, v162
    v_cmp_lt_i32 s[86:87], 8, v162
    v_cmp_lt_i32 s[88:89], 12, v162
    v_cmp_lt_i32 s[90:91], 16, v162
    v_cmp_lt_i32 s[92:93], 20, v162
    v_cmp_lt_i32 s[94:95], 24, v162
    v_cmp_lt_i32 s[96:97], 28, v162
    v_cmp_lt_i32 s[98:99], 32, v162
    s_mov_b64 exec, s[64:65]
    buffer_load_dwordx3 v[42:44], v164, s[20:23], 0 offen offset:0
    s_mov_b64 exec, s[66:67]
    buffer_load_dwordx3 v[46:48], v164, s[20:23], 0 offen offset:48
    s_mov_b64 exec, s[68:69]
    buffer_load_dwordx3 v[50:52], v164, s[20:23], 0 offen offset:96
    s_mov_b64 exec, s[70:71]
    s_cbranch_execz K2_SKL0
    buffer_load_dwordx3 v[54:56], v164, s[20:23], 0 offen offset:144
    s_mov_b64 exec, s[72:73]
    s_cbranch_execz K2_SKL0
    buffer_load_dwordx3 v[58:60], v164, s[20:23], 0 offen offset:192
    s_mov_b64 exec, s[74:75]
    s_cbranch_execz K2_SKL0
    buffer_load_dwordx3 v[62:64], v164, s[20:23], 0 offen offset:240
    s_mov_b64 exec, s[76:77]
    s_cbranch_execz K2_SKL0
    buffer_load_dwordx3 v[66:68], v164, s[20:23], 0 offen offset:288
    s_mov_b64 exec, s[78:79]
    s_cbranch_execz K2_SKL0
    buffer_load_dwordx3 v[70:72], v164, s[20:23], 0 offen offset:336
    s_mov_b64 exec, s[80:81]
    s_cbranch_execz K2_SKL0
    buffer_load_dwordx3 v[74:76], v164, s[20:23], 0 offen offset:384
K2_SKL0:
    s_mov_b64 exec, -1
    s_mov_b64 exec, s[82:83]
    s_cbranch_execz K2_SKL1
    buffer_load_dwordx3 v[78:80], v165, s[20:23], 0 offen offset:0
    s_mov_b64 exec, s[84:85]
    s_cbranch_execz K2_SKL1
    buffer_load_dwordx3 v[82:84], v165, s[20:23], 0 offen offset:48
    s_mov_b64 exec, s[86:87]
    s_cbranch_execz K2_SKL1
    buffer_load_dwordx3 v[86:88], v165, s[20:23], 0 offen offset:96
    s_mov_b64 exec, s[88:89]
    s_cbranch_execz K2_SKL1
    buffer_load_dwordx3 v[90:92], v165, s[20:23], 0 offen offset:144
    s_mov_b64 exec, s[90:91]
    s_cbranch_execz K2_SKL1
    buffer_load_dwordx3 v[94:96], v165, s[20:23], 0 offen offset:192
    s_mov_b64 exec, s[92:93]
    s_cbranch_execz K2_SKL1
    buffer_load_dwordx3 v[98:100], v165, s[20:23], 0 offen offset:240
    s_mov_b64 exec, s[94:95]
    s_cbranch_execz K2_SKL1
    buffer_load_dwordx3 v[102:104], v165, s[20:23], 0 offen offset:288
    s_mov_b64 exec, s[96:97]
    s_cbranch_execz K2_SKL1
    buffer_load_dwordx3 v[106:108], v165, s[20:23], 0 offen offset:336
    s_mov_b64 exec, s[98:99]
    s_cbranch_execz K2_SKL1
    buffer_load_dwordx3 v[110:112], v165, s[20:23], 0 offen offset:384
K2_SKL1:
    s_mov_b64 exec, -1
    v_mov_b32 v163, 512
    v_max_u32 v162, v135, v137
    ds_max_u32 v163, v162
    s_cmp_eq_u32 s39, 0
    s_cbranch_scc1 K2_NOLD
    v_lshlrev_b32 v152, 4, v133
    s_lshl_b32 s59, s32, 10
    s_add_u32 m0, s59, 146816
    s_add_u32 s14, s59, 17825792
    buffer_load_dwordx4 v152, s[20:23], s14 offen lds
    s_min_u32 s60, s32, 4
    s_lshl_b32 s59, s60, 10
    s_add_u32 s61, s59, 159104
    s_add_u32 s14, s59, 17838080
    s_cmp_eq_u32 s60, 4
    s_cselect_b32 s14, 17858560, s14
    s_cselect_b32 m0, 118144, s61
    s_nop 0
    buffer_load_dwordx4 v152, s[20:23], s14 offen lds
    s_cmp_gt_u32 s32, 7
    s_cselect_b32 s61, 4, 0
    s_sub_u32 s61, s32, s61
    s_lshl_b32 s59, s61, 4
    s_add_u32 s59, s59, s33
    v_lshrrev_b32 v142, 3, v133
    v_add_u32 v142, s59, v142
    v_add_u32 v144, 8, v142
    s_lshr_b32 s59, s61, 1
    s_lshl_b32 s59, s59, 13
    s_and_b32 s60, s61, 1
    s_lshl_b32 s60, s60, 11
    s_add_u32 s59, s59, s60
    s_add_u32 m0, s59, 114048
    s_nop 0
    buffer_load_dwordx4 v[142:143], s[16:19], 0 idxen offen lds
    s_add_u32 m0, s59, 115072
    s_nop 0
    buffer_load_dwordx4 v[144:145], s[16:19], 0 idxen offen lds
    v_lshlrev_b32 v152, 1, v133
    buffer_load_ushort v166, v152, s[28:31], 0 offen
    v_add_u32 v152, s33, v132
    buffer_load_dwordx4 v[34:37], v152, s[24:27], 0 idxen

    s_waitcnt vmcnt(6)
    s_branch K2_RECOK
K2_NOLD:
    s_waitcnt vmcnt(0)
K2_RECOK:

    s_mov_b64 exec, s[64:65]
    v_lshrrev_b32 v114, 18, v44
    ds_add_rtn_u32 v45, v114, v139 offset:0

    s_mov_b64 exec, s[66:67]
    v_lshrrev_b32 v115, 18, v48
    ds_add_rtn_u32 v49, v115, v139 offset:0

    s_mov_b64 exec, s[68:69]
    v_lshrrev_b32 v116, 18, v52
    ds_add_rtn_u32 v53, v116, v139 offset:0

    s_mov_b64 exec, s[70:71]
    s_cbranch_execz K2_SKA0
    v_lshrrev_b32 v117, 18, v56
    ds_add_rtn_u32 v57, v117, v139 offset:0

    s_mov_b64 exec, s[72:73]
    s_cbranch_execz K2_SKA0
    v_lshrrev_b32 v118, 18, v60
    ds_add_rtn_u32 v61, v118, v139 offset:0

    s_mov_b64 exec, s[74:75]
    s_cbranch_execz K2_SKA0
    v_lshrrev_b32 v119, 18, v64
    ds_add_rtn_u32 v65, v119, v139 offset:0

    s_mov_b64 exec, s[76:77]
    s_cbranch_execz K2_SKA0
    v_lshrrev_b32 v120, 18, v68
    ds_add_rtn_u32 v69, v120, v139 offset:0

    s_mov_b64 exec, s[78:79]
    s_cbranch_execz K2_SKA0
    v_lshrrev_b32 v121, 18, v72
    ds_add_rtn_u32 v73, v121, v139 offset:0

    s_mov_b64 exec, s[80:81]
    s_cbranch_execz K2_SKA0
    v_lshrrev_b32 v122, 18, v76
    ds_add_rtn_u32 v77, v122, v139 offset:0

K2_SKA0:
    s_mov_b64 exec, s[82:83]
    s_cbranch_execz K2_SKA1
    v_lshrrev_b32 v123, 18, v80
    ds_add_rtn_u32 v81, v123, v139 offset:0

    s_mov_b64 exec, s[84:85]
    s_cbranch_execz K2_SKA1
    v_lshrrev_b32 v124, 18, v84
    ds_add_rtn_u32 v85, v124, v139 offset:0

    s_mov_b64 exec, s[86:87]
    s_cbranch_execz K2_SKA1
    v_lshrrev_b32 v125, 18, v88
    ds_add_rtn_u32 v89, v125, v139 offset:0

    s_mov_b64 exec, s[88:89]
    s_cbranch_execz K2_SKA1
    v_lshrrev_b32 v126, 18, v92
    ds_add_rtn_u32 v93, v126, v139 offset:0

    s_mov_b64 exec, s[90:91]
    s_cbranch_execz K2_SKA1
    v_lshrrev_b32 v127, 18, v96
    ds_add_rtn_u32 v97, v127, v139 offset:0

    s_mov_b64 exec, s[92:93]
    s_cbranch_execz K2_SKA1
    v_lshrrev_b32 v128, 18, v100
    ds_add_rtn_u32 v101, v128, v139 offset:0

    s_mov_b64 exec, s[94:95]
    s_cbranch_execz K2_SKA1
    v_lshrrev_b32 v129, 18, v104
    ds_add_rtn_u32 v105, v129, v139 offset:0

    s_mov_b64 exec, s[96:97]
    s_cbranch_execz K2_SKA1
    v_lshrrev_b32 v130, 18, v108
    ds_add_rtn_u32 v109, v130, v139 offset:0

    s_mov_b64 exec, s[98:99]
    s_cbranch_execz K2_SKA1
    v_lshrrev_b32 v131, 18, v112
    ds_add_rtn_u32 v113, v131, v139 offset:0

K2_SKA1:
    s_mov_b64 exec, -1
    s_waitcnt vmcnt(0) lgkmcnt(0)
    s_barrier

    v_lshlrev_b32 v150, 3, v133
    ds_read_b64 v[152:153], v150 offset:0
    ds_read_b32 v154, v163
    s_waitcnt lgkmcnt(0)
    v_readfirstlane_b32 s58, v154
    v_add_u32 v155, v152, v153
    s_mov_b32 s61, 0
K2_SCAN:
    v_mov_b32 v156, v155
    s_nop 1
    v_add_u32_dpp v156, v156, v156 row_shr:1 row_mask:0xf bank_mask:0xf
    s_nop 1
    v_add_u32_dpp v156, v156, v156 row_shr:2 row_mask:0xf bank_mask:0xf
    s_nop 1
    v_add_u32_dpp v156, v156, v156 row_shr:4 row_mask:0xf bank_mask:0xf
    s_nop 1
    v_add_u32_dpp v156, v156, v156 row_shr:8 row_mask:0xf bank_mask:0xf
    s_nop 1
    v_add_u32_dpp v156, v156, v156 row_bcast:15 row_mask:0xa bank_mask:0xf
    s_nop 1
    v_add_u32_dpp v156, v156, v156 row_bcast:31 row_mask:0xc bank_mask:0xf
    s_nop 1
    v_readlane_b32 s34, v156, 63
    s_cmp_lg_u32 s57, 36
    s_cbranch_scc1 K2_CAPOK
    s_cmp_gt_u32 s58, 36
    s_cbranch_scc1 K2_TOSLOW
    s_cmp_gt_u32 s34, 3456
    s_cbranch_scc0 K2_CAPOK
K2_TOSLOW:
    s_mov_b32 s57, 12
    s_barrier
    s_branch K2_ROUND
K2_CAPOK:
    s_cmp_lg_u32 s61, 0
    s_cbranch_scc1 K2_SCANDONE
    v_mov_b32 v157, v155
    s_nop 1
    v_add_u32_dpp v157, v155, v155 quad_perm:[1,0,3,2] row_mask:0xf bank_mask:0xf
    v_cmp_gt_u32 vcc, 31, v157
    v_cmp_gt_u32 s[44:45], s34, v156
    s_and_b64 vcc, vcc, s[44:45]
    s_mov_b32 s44, 0xaaaaaaaa
    s_mov_b32 s45, 0xaaaaaaaa
    s_and_b64 vcc, vcc, s[44:45]
    s_cbranch_vccz K2_SCANDONE
    v_mov_b32 v151, v157
    s_nop 1
    v_add_u32_dpp v151, v157, v157 quad_perm:[2,3,0,1] row_mask:0xf bank_mask:0xf
    v_sub_u32 v151, 0, v151
    v_and_b32 v151, 31, v151
    s_mov_b32 s44, 0x88888888
    s_mov_b32 s45, 0x88888888
    v_cndmask_b32 v151, 0, v151, s[44:45]
    v_add_u32 v155, v155, v151
    s_mov_b32 s61, 1
    s_branch K2_SCAN
K2_SCANDONE:
    v_sub_u32 v156, v156, v155
    v_add_u32 v157, v156, v152
    ds_write_b64 v150, v[156:157] offset:576

    s_mov_b64 exec, s[64:65]
    ds_read_b32 v114, v114 offset:576
    s_mov_b64 exec, s[66:67]
    ds_read_b32 v115, v115 offset:576
    s_mov_b64 exec, s[68:69]
    ds_read_b32 v116, v116 offset:576
    s_mov_b64 exec, s[70:71]
    s_cbranch_execz K2_SKB0
    ds_read_b32 v117, v117 offset:576
    s_mov_b64 exec, s[72:73]
    s_cbranch_execz K2_SKB0
    ds_read_b32 v118, v118 offset:576
    s_mov_b64 exec, s[74:75]
    s_cbranch_execz K2_SKB0
    ds_read_b32 v119, v119 offset:576
    s_mov_b64 exec, s[76:77]
    s_cbranch_execz K2_SKB0
    ds_read_b32 v120, v120 offset:576
    s_mov_b64 exec, s[78:79]
    s_cbranch_execz K2_SKB0
    ds_read_b32 v121, v121 offset:576
    s_mov_b64 exec, s[80:81]
    s_cbranch_execz K2_SKB0
    ds_read_b32 v122, v122 offset:576
K2_SKB0:
    s_mov_b64 exec, s[82:83]
    s_cbranch_execz K2_SKB1
    ds_read_b32 v123, v123 offset:576
    s_mov_b64 exec, s[84:85]
    s_cbranch_execz K2_SKB1
    ds_read_b32 v124, v124 offset:576
    s_mov_b64 exec, s[86:87]
    s_cbranch_execz K2_SKB1
    ds_read_b32 v125, v125 offset:576
    s_mov_b64 exec, s[88:89]
    s_cbranch_execz K2_SKB1
    ds_read_b32 v126, v126 offset:576
    s_mov_b64 exec, s[90:91]
    s_cbranch_execz K2_SKB1
    ds_read_b32 v127, v127 offset:576
    s_mov_b64 exec, s[92:93]
    s_cbranch_execz K2_SKB1
    ds_read_b32 v128, v128 offset:576
    s_mov_b64 exec, s[94:95]
    s_cbranch_execz K2_SKB1
    ds_read_b32 v129, v129 offset:576
    s_mov_b64 exec, s[96:97]
    s_cbranch_execz K2_SKB1
    ds_read_b32 v130, v130 offset:576
    s_mov_b64 exec, s[98:99]
    s_cbranch_execz K2_SKB1
    ds_read_b32 v131, v131 offset:576
K2_SKB1:
    s_waitcnt lgkmcnt(0)
    s_mov_b64 exec, s[64:65]
    v_add_lshl_u32 v114, v114, v45, 2
    ds_write_b32 v114, v44 offset:1536
    v_lshlrev_b32 v114, 1, v114
    ds_write_b64 v114, v[42:43] offset:15360

    s_mov_b64 exec, s[66:67]
    v_add_lshl_u32 v115, v115, v49, 2
    ds_write_b32 v115, v48 offset:1536
    v_lshlrev_b32 v115, 1, v115
    ds_write_b64 v115, v[46:47] offset:15360

    s_mov_b64 exec, s[68:69]
    v_add_lshl_u32 v116, v116, v53, 2
    ds_write_b32 v116, v52 offset:1536
    v_lshlrev_b32 v116, 1, v116
    ds_write_b64 v116, v[50:51] offset:15360

    s_mov_b64 exec, s[70:71]
    s_cbranch_execz K2_SKC0
    v_add_lshl_u32 v117, v117, v57, 2
    ds_write_b32 v117, v56 offset:1536
    v_lshlrev_b32 v117, 1, v117
    ds_write_b64 v117, v[54:55] offset:15360

    s_mov_b64 exec, s[72:73]
    s_cbranch_execz K2_SKC0
    v_add_lshl_u32 v118, v118, v61, 2
    ds_write_b32 v118, v60 offset:1536
    v_lshlrev_b32 v118, 1, v118
    ds_write_b64 v118, v[58:59] offset:15360

    s_mov_b64 exec, s[74:75]
    s_cbranch_execz K2_SKC0
    v_add_lshl_u32 v119, v119, v65, 2
    ds_write_b32 v119, v64 offset:1536
    v_lshlrev_b32 v119, 1, v119
    ds_write_b64 v119, v[62:63] offset:15360

    s_mov_b64 exec, s[76:77]
    s_cbranch_execz K2_SKC0
    v_add_lshl_u32 v120, v120, v69, 2
    ds_write_b32 v120, v68 offset:1536
    v_lshlrev_b32 v120, 1, v120
    ds_write_b64 v120, v[66:67] offset:15360

    s_mov_b64 exec, s[78:79]
    s_cbranch_execz K2_SKC0
    v_add_lshl_u32 v121, v121, v73, 2
    ds_write_b32 v121, v72 offset:1536
    v_lshlrev_b32 v121, 1, v121
    ds_write_b64 v121, v[70:71] offset:15360

    s_mov_b64 exec, s[80:81]
    s_cbranch_execz K2_SKC0
    v_add_lshl_u32 v122, v122, v77, 2
    ds_write_b32 v122, v76 offset:1536
    v_lshlrev_b32 v122, 1, v122
    ds_write_b64 v122, v[74:75] offset:15360

K2_SKC0:
    s_mov_b64 exec, s[82:83]
    s_cbranch_execz K2_SKC1
    v_add_lshl_u32 v123, v123, v81, 2
    ds_write_b32 v123, v80 offset:1536
    v_lshlrev_b32 v123, 1, v123
    ds_write_b64 v123, v[78:79] offset:15360

    s_mov_b64 exec, s[84:85]
    s_cbranch_execz K2_SKC1
    v_add_lshl_u32 v124, v124, v85, 2
    ds_write_b32 v124, v84 offset:1536
    v_lshlrev_b32 v124, 1, v124
    ds_write_b64 v124, v[82:83] offset:15360

    s_mov_b64 exec, s[86:87]
    s_cbranch_execz K2_SKC1
    v_add_lshl_u32 v125, v125, v89, 2
    ds_write_b32 v125, v88 offset:1536
    v_lshlrev_b32 v125, 1, v125
    ds_write_b64 v125, v[86:87] offset:15360

    s_mov_b64 exec, s[88:89]
    s_cbranch_execz K2_SKC1
    v_add_lshl_u32 v126, v126, v93, 2
    ds_write_b32 v126, v92 offset:1536
    v_lshlrev_b32 v126, 1, v126
    ds_write_b64 v126, v[90:91] offset:15360

    s_mov_b64 exec, s[90:91]
    s_cbranch_execz K2_SKC1
    v_add_lshl_u32 v127, v127, v97, 2
    ds_write_b32 v127, v96 offset:1536
    v_lshlrev_b32 v127, 1, v127
    ds_write_b64 v127, v[94:95] offset:15360

    s_mov_b64 exec, s[92:93]
    s_cbranch_execz K2_SKC1
    v_add_lshl_u32 v128, v128, v101, 2
    ds_write_b32 v128, v100 offset:1536
    v_lshlrev_b32 v128, 1, v128
    ds_write_b64 v128, v[98:99] offset:15360

    s_mov_b64 exec, s[94:95]
    s_cbranch_execz K2_SKC1
    v_add_lshl_u32 v129, v129, v105, 2
    ds_write_b32 v129, v104 offset:1536
    v_lshlrev_b32 v129, 1, v129
    ds_write_b64 v129, v[102:103] offset:15360

    s_mov_b64 exec, s[96:97]
    s_cbranch_execz K2_SKC1
    v_add_lshl_u32 v130, v130, v109, 2
    ds_write_b32 v130, v108 offset:1536
    v_lshlrev_b32 v130, 1, v130
    ds_write_b64 v130, v[106:107] offset:15360

    s_mov_b64 exec, s[98:99]
    s_cbranch_execz K2_SKC1
    v_add_lshl_u32 v131, v131, v113, 2
    ds_write_b32 v131, v112 offset:1536
    v_lshlrev_b32 v131, 1, v131
    ds_write_b64 v131, v[110:111] offset:15360

K2_SKC1:
    s_mov_b64 exec, -1
    s_cmp_lg_u32 s9, 0
    s_cbranch_scc1 K2_NOATAB
    s_mov_b32 s9, 1

    v_lshlrev_b32 v162, 4, v132
    v_cmp_gt_u32 vcc, 104, v132
    s_mov_b64 exec, vcc
    ds_write_b128 v162, v[34:37] offset:43008
    s_mov_b64 exec, -1
    s_cmp_lg_u32 s32, 3
    s_cbranch_scc1 K2_NOWXF
    v_lshlrev_b32 v166, 16, v166
    v_mul_f32 v166, 0xbf317218, v166
    v_lshlrev_b32 v167, 2, v133
    ds_write_b32 v167, v166 offset:1280
K2_NOWXF:
    v_lshlrev_b32 v167, 4, v133
    v_add_u32 v167, 146816, v167
    s_cmp_lt_u32 s32, 4
    s_cbranch_scc1 K2_ATABEND
    s_and_b32 s60, s32, 1
    s_lshl_b32 s59, s60, 12
    s_add_u32 s61, s59, 16384
    v_subrev_u32 v162, s61, v158
    v_xor_b32 v164, 16, v162
    v_xor_b32 v165, 32, v162
    v_xor_b32 v166, 48, v162
    ds_read_b128 v[2:5], v162
    ds_read_b128 v[6:9], v164
    ds_read_b128 v[10:13], v165
    ds_read_b128 v[14:17], v166
    v_add_u32 v162, s59, v167

    ds_read_b128 v[18:21], v162 offset:8192
    ds_read_b128 v[22:25], v162 offset:9216
    ds_read_b128 v[26:29], v162 offset:10240
    ds_read_b128 v[30:33], v162 offset:11264
    v_and_b32 v164, 31, v133
    v_lshrrev_b32 v165, 5, v133
    v_mul_u32_u24 v164, 208, v164
    v_lshl_add_u32 v164, v165, 3, v164
    s_lshr_b32 s59, s32, 1
    s_sub_u32 s59, s59, 2
    s_mul_i32 s60, s60, 6656
    s_lshl_b32 s61, s59, 6
    s_add_u32 s61, s61, s60
    s_add_u32 s61, s61, 44672
    v_add_u32 v164, s61, v164
    s_waitcnt lgkmcnt(0)

    v_mfma_f32_32x32x16_bf16 v[142:157], v[2:5], v[18:21], 0
    v_mfma_f32_32x32x16_bf16 v[142:157], v[6:9], v[22:25], v[142:157]
    v_mfma_f32_32x32x16_bf16 v[142:157], v[10:13], v[26:29], v[142:157]
    v_mfma_f32_32x32x16_bf16 v[142:157], v[14:17], v[30:33], v[142:157]
    s_nop 7
    s_nop 3
    v_pk_mul_f32 v[142:143], v[142:143], s[46:47]
    v_pk_mul_f32 v[144:145], v[144:145], s[46:47]
    v_cvt_pk_bf16_f32 v142, v142, v143
    v_cvt_pk_bf16_f32 v143, v144, v145
    ds_write_b64 v164, v[142:143] offset:0

    s_cmp_eq_u32 s59, 3
    s_cbranch_scc1 K2_ATABEND
    v_pk_mul_f32 v[146:147], v[146:147], s[46:47]
    v_pk_mul_f32 v[148:149], v[148:149], s[46:47]
    v_cvt_pk_bf16_f32 v146, v146, v147
    v_cvt_pk_bf16_f32 v147, v148, v149
    ds_write_b64 v164, v[146:147] offset:16

    v_pk_mul_f32 v[150:151], v[150:151], s[46:47]
    v_pk_mul_f32 v[152:153], v[152:153], s[46:47]
    v_cvt_pk_bf16_f32 v150, v150, v151
    v_cvt_pk_bf16_f32 v151, v152, v153
    ds_write_b64 v164, v[150:151] offset:32

    v_pk_mul_f32 v[154:155], v[154:155], s[46:47]
    v_pk_mul_f32 v[156:157], v[156:157], s[46:47]
    v_cvt_pk_bf16_f32 v154, v154, v155
    v_cvt_pk_bf16_f32 v155, v156, v157
    ds_write_b64 v164, v[154:155] offset:48

K2_ATABEND:
    ds_read_b128 v[2:5], v167 offset:0
    ds_read_b128 v[6:9], v167 offset:1024
    ds_read_b128 v[10:13], v167 offset:2048
    ds_read_b128 v[14:17], v167 offset:3072
    ds_read_b128 v[18:21], v167 offset:4096
    ds_read_b128 v[22:25], v167 offset:5120
    ds_read_b128 v[26:29], v167 offset:6144
    ds_read_b128 v[30:33], v167 offset:7168
    v_lshlrev_b32 v162, 3, v133
    v_add_u32 v162, 118144, v162
    ds_read_b64 v[34:35], v162
    ds_read_b64 v[38:39], v162 offset:512
K2_NOATAB:
    s_add_u32 s59, s34, 31
    s_lshr_b32 s59, s59, 5
    s_lshr_b32 s60, s32, 2
    s_and_b32 s61, s32, 3
    s_cmp_eq_u32 s60, 0
    s_cselect_b32 s35, 0, 140
    s_cselect_b32 s36, 35, 19
    s_cmp_eq_u32 s60, 2
    s_cselect_b32 s35, 216, s35
    s_cselect_b32 s36, 10, s36
    s_mul_i32 s61, s61, s36
    s_add_u32 s35, s35, s61
    s_add_u32 s36, s36, s35
    s_mul_i32 s35, s35, s59
    s_mul_i32 s36, s36, s59
    s_lshr_b32 s35, s35, 8
    s_lshr_b32 s36, s36, 8
    s_cmp_eq_u32 s60, 0
    s_cbranch_scc0 K2_P1
    s_setprio 2
K2_P1:
    s_cmp_eq_u32 s60, 1
    s_cbranch_scc0 K2_P2
    s_setprio 1
K2_P2:
    s_lshl_b32 s68, s35, 5
    s_lshl_b32 s69, s36, 5
    s_min_u32 s69, s69, s34

    v_and_b32 v44, 7, v133
    v_lshrrev_b32 v45, 4, v133
    v_xor_b32 v44, v44, v45
    v_lshlrev_b32 v143, 4, v44
    v_lshlrev_b32 v147, 4, v44
    v_xor_b32 v145, 64, v143
    v_xor_b32 v149, 64, v143
    v_and_b32 v44, 31, v133
    v_lshrrev_b32 v45, 5, v133
    v_bfe_u32 v46, v44, 1, 3
    v_lshlrev_b32 v45, 2, v45
    v_xor_b32 v45, v45, v46
    v_lshlrev_b32 v45, 4, v45
    v_lshl_add_u32 v45, v44, 7, v45
    v_add_u32 v158, s43, v45
    v_xor_b32 v159, 16, v158
    v_xor_b32 v160, 32, v158
    v_xor_b32 v161, 48, v158

    v_and_b32 v44, 31, v133
    v_lshrrev_b32 v45, 5, v133
    s_lshl_b32 s59, s35, 7
    v_lshl_add_u32 v163, v44, 2, s59
    v_lshrrev_b32 v46, 3, v133
    v_lshl_add_u32 v164, v46, 2, s59
    v_lshlrev_b32 v165, 3, v45
    v_add_u32 v165, 1152, v165
    s_lshl_b32 s59, s32, 11
    s_add_u32 s59, s59, 89376
    v_lshl_add_u32 v166, v44, 6, s59
    v_bfe_u32 v46, v133, 2, 2
    v_lshl_add_u32 v46, v45, 2, v46
    v_lshlrev_b32 v0, 6, v46
    v_bfe_u32 v46, v133, 4, 1
    v_lshl_add_u32 v0, v46, 5, v0
    v_and_b32 v46, 3, v133
    v_lshl_add_u32 v0, v46, 3, v0
    v_add_u32 v0, s59, v0
    v_mov_b32 v1, 0
    s_mov_b32 s37, 0
    s_waitcnt lgkmcnt(0)
    s_barrier

    s_cmp_ge_u32 s35, s36
    s_cbranch_scc1 K2_MAINDONE

    ds_read_u16 v142, v164 offset:1536
    ds_read_u16 v144, v164 offset:1568
    ds_read_u16 v146, v164 offset:1600
    ds_read_u16 v148, v164 offset:1632
    ds_read_u16 v153, v163 offset:1536
    v_add_u32 v164, 128, v164
    ds_read_u16 v162, v163 offset:1538
    v_add_u32 v163, 128, v163
    s_mov_b32 s73, 1
    s_mov_b32 s74, 1
    v_mov_b64 v[90:91], 0
    v_mov_b64 v[92:93], 0
    v_mov_b64 v[94:95], 0
    v_mov_b64 v[96:97], 0
    v_mov_b64 v[126:127], 0
    v_mov_b64 v[128:129], 0
    v_mov_b64 v[130:131], 0
    v_mov_b64 v[132:133], 0
    v_mov_b64 v[122:123], 0
    v_mov_b64 v[124:125], 0
    s_waitcnt lgkmcnt(0)
    v_readfirstlane_b32 s70, v162
    v_cmp_ne_u32 vcc, 0xffff, v162
    s_mov_b64 s[44:45], vcc
    s_lshr_b32 s70, s70, 4
    s_lshl_b32 s59, s32, 2
    v_mov_b32 v134, s59
    s_add_u32 s60, s70, 1
    v_mov_b32 v135, s60
    ds_write_b32 v134, v135 offset:528

    s_mov_b32 m0, s43
    s_nop 0
    buffer_load_dwordx4 v[142:143], s[16:19], 0 idxen offen lds
    s_add_u32 m0, s43, 1024
    s_nop 0
    buffer_load_dwordx4 v[144:145], s[16:19], 0 idxen offen lds
    s_add_u32 m0, s43, 2048
    s_nop 0
    buffer_load_dwordx4 v[146:147], s[16:19], 0 idxen offen lds
    s_add_u32 m0, s43, 3072
    s_nop 0
    buffer_load_dwordx4 v[148:149], s[16:19], 0 idxen offen lds
    s_mov_b64 exec, s[50:51]
    buffer_load_dwordx3 v[150:152], v153, s[24:27], 0 idxen
    s_mov_b64 exec, -1
    ds_read_u16 v142, v164 offset:1536
    ds_read_u16 v144, v164 offset:1568
    ds_read_u16 v146, v164 offset:1600
    ds_read_u16 v148, v164 offset:1632
    ds_read_u16 v153, v163 offset:1536
    v_add_u32 v164, 128, v164
    s_mov_b64 exec, s[44:45]
    ds_read_b128 v[154:157], v162 offset:43008
    s_mov_b64 exec, -1
    s_and_b32 s59, s70, -2
    s_sub_u32 s60, s59, s37
    s_mov_b32 s37, s59
    s_lshl_b32 s61, s60, 4
    s_lshl_b32 s60, s60, 3
    v_subrev_u32 v165, s61, v165
    v_subrev_u32 v166, s60, v166
    s_lshl_b32 s59, s37, 2
    v_mov_b32 v134, s59
    ds_read_b32 v135, v134 offset:608
    s_waitcnt lgkmcnt(0)
    v_readfirstlane_b32 s38, v135

    v_mbcnt_lo_u32_b32 v134, -1, 0
    v_mbcnt_hi_u32_b32 v134, -1, v134
    s_lshl_b32 s59, s37, 1
    s_add_u32 s59, s59, 44672
    v_and_b32 v135, 31, v134
    v_lshrrev_b32 v134, 5, v134
    v_lshl_add_u32 v134, v134, 3, s59
    v_mad_u32_u24 v134, v135, s62, v134
    v_add_u32 v135, 6656, v134
    ds_read2_b32 v[36:37], v134 offset0:0 offset1:1
    ds_read2_b32 v[40:41], v135 offset0:0 offset1:1

    s_waitcnt vmcnt(0)
    ds_read_b128 v[106:109], v158
    ds_read_b128 v[110:113], v159
    ds_read_b128 v[114:117], v160
    ds_read_b128 v[118:121], v161
    v_lshrrev_b32 v167, 1, v162
    v_add_u32 v167, v167, v166
    v_add_u32 v162, v162, v165
    v_lshlrev_b32 v134, 1, v163
    s_waitcnt lgkmcnt(4)
    s_and_b64 exec, s[44:45], s[50:51]
    v_pk_add_f32 v[154:155], v[154:155], v[150:151] neg_lo:[0,1] neg_hi:[0,1]
    v_sub_f32 v156, v156, v152
    v_mul_f32 v157, v154, v154
    v_fmac_f32 v157, v155, v155
    v_fmac_f32 v157, v156, v156
    v_cvt_pk_bf16_f32 v123, v155, v156
    v_cvt_pk_bf16_f32 v122, v157, v157
    v_cvt_pk_bf16_f32 v154, 1.0, v154
    ds_write2_b32 v167, v154, v123 offset0:0 offset1:1
    s_and_b64 exec, s[44:45], s[48:49]
    ds_read_b64 v[122:123], v134 offset:15104
    s_mov_b64 exec, s[44:45]
    ds_read_b64 v[124:125], v162
    s_mov_b64 exec, -1
    s_and_b64 s[40:41], s[44:45], s[50:51]
    s_waitcnt lgkmcnt(0)
    s_mov_b32 m0, s43
    s_nop 0
    buffer_load_dwordx4 v[142:143], s[16:19], 0 idxen offen lds
    s_add_u32 m0, s43, 1024
    s_nop 0
    buffer_load_dwordx4 v[144:145], s[16:19], 0 idxen offen lds
    s_add_u32 m0, s43, 2048
    s_nop 0
    buffer_load_dwordx4 v[146:147], s[16:19], 0 idxen offen lds
    s_add_u32 m0, s43, 3072
    s_nop 0
    buffer_load_dwordx4 v[148:149], s[16:19], 0 idxen offen lds
    s_mov_b64 exec, s[50:51]
    buffer_load_dwordx3 v[150:152], v153, s[24:27], 0 idxen
    s_mov_b64 exec, -1
    ds_read_u16 v142, v164 offset:1536
    ds_read_u16 v144, v164 offset:1568
    ds_read_u16 v146, v164 offset:1600
    ds_read_u16 v148, v164 offset:1632
    ds_read_u16 v153, v163 offset:1664
    v_add_u32 v164, 128, v164
    ds_read_u16 v162, v163 offset:1538
    v_add_u32 v163, 128, v163
    s_mov_b32 s39, 0
    v_mfma_f32_32x32x16_bf16 v[74:89], v[122:125], v[34:37], 0
    v_mfma_f32_32x32x16_bf16 v[74:89], v[106:109], v[2:5], v[74:89]
    v_mfma_f32_32x32x16_bf16 v[74:89], v[110:113], v[6:9], v[74:89]
    v_mfma_f32_32x32x16_bf16 v[74:89], v[114:117], v[10:13], v[74:89]
    v_mfma_f32_32x32x16_bf16 v[74:89], v[118:121], v[14:17], v[74:89]
    s_nop 7
    s_nop 3
K2_LOOP:
    s_waitcnt lgkmcnt(0)
    v_cmp_ne_u32 vcc, 0xffff, v162
    s_mov_b32 s42, 0
    s_add_u32 s59, s35, 1
    s_cmp_ge_u32 s59, s36
    s_cselect_b64 s[44:45], 0, vcc
    s_cbranch_scc1 K2_NOREBASE
    s_add_u32 s59, s59, 1
    s_lshl_b32 s59, s59, 5
    s_min_u32 s59, s59, s34
    s_cmp_le_u32 s59, s38
    s_cbranch_scc1 K2_NOREBASE
    s_mov_b32 s71, s37
    v_readfirstlane_b32 s59, v162
    s_mov_b32 s42, 1
    s_lshr_b32 s59, s59, 4
    s_and_b32 s59, s59, -2

    s_sub_u32 s60, s59, s37
    s_mov_b32 s37, s59
    s_lshl_b32 s61, s60, 4
    s_lshl_b32 s60, s60, 3
    v_subrev_u32 v165, s61, v165
    v_subrev_u32 v166, s60, v166
    s_lshl_b32 s59, s37, 2
    v_mov_b32 v134, s59
    ds_read_b32 v135, v134 offset:608
    s_waitcnt lgkmcnt(0)
    v_readfirstlane_b32 s38, v135

K2_NOREBASE:
    s_mov_b64 exec, s[44:45]
    ds_read_b128 v[154:157], v162 offset:43008
    s_mov_b64 exec, -1
    s_cmp_eq_u32 s74, 0
    s_cbranch_scc1 K2_MZAa
    v_mfma_f32_32x32x16_bf16 v[58:73], v[90:93], v[126:129], 0
    s_mov_b32 s74, 0
    s_branch K2_MZAb
K2_MZAa:
    v_mfma_f32_32x32x16_bf16 v[58:73], v[90:93], v[126:129], v[58:73]
K2_MZAb:
    v_exp_f32 v134, v74
    v_exp_f32 v135, v75
    v_exp_f32 v136, v76
    v_exp_f32 v137, v77
    v_pk_add_f32 v[134:135], v[134:135], 1.0 op_sel_hi:[1,0]
    v_pk_add_f32 v[136:137], v[136:137], 1.0 op_sel_hi:[1,0]
    v_mfma_f32_32x32x16_bf16 v[58:73], v[94:97], v[130:133], v[58:73]
    ds_read_b64_tr_b16 v[126:127], v0 offset:0
    ds_read_b64_tr_b16 v[128:129], v0 offset:512
    ds_read_b64_tr_b16 v[130:131], v0 offset:1024
    ds_read_b64_tr_b16 v[132:133], v0 offset:1536
    s_mov_b64 exec, s[40:41]
    ds_write2_b32 v167, v1, v1 offset0:0 offset1:1
    s_mov_b64 exec, -1
    v_rcp_f32 v134, v134
    v_rcp_f32 v135, v135
    v_rcp_f32 v136, v136
    v_rcp_f32 v137, v137
    v_pk_mul_f32 v[134:135], v[134:135], v[74:75]
    v_pk_mul_f32 v[136:137], v[136:137], v[76:77]
    v_cvt_pk_bf16_f32 v74, v134, v135
    v_cvt_pk_bf16_f32 v75, v136, v137
    v_mfma_f32_32x32x16_bf16 v[90:105], v[106:109], v[18:21], 0
    v_exp_f32 v138, v78
    v_exp_f32 v139, v79
    v_exp_f32 v140, v80
    v_exp_f32 v141, v81
    v_pk_add_f32 v[138:139], v[138:139], 1.0 op_sel_hi:[1,0]
    v_pk_add_f32 v[140:141], v[140:141], 1.0 op_sel_hi:[1,0]
    v_mfma_f32_32x32x16_bf16 v[90:105], v[110:113], v[22:25], v[90:105]
    v_rcp_f32 v138, v138
    v_rcp_f32 v139, v139
    v_rcp_f32 v140, v140
    v_rcp_f32 v141, v141
    v_pk_mul_f32 v[138:139], v[138:139], v[78:79]
    v_pk_mul_f32 v[140:141], v[140:141], v[80:81]
    v_cvt_pk_bf16_f32 v76, v138, v139
    v_cvt_pk_bf16_f32 v77, v140, v141
    v_mfma_f32_32x32x16_bf16 v[90:105], v[114:117], v[26:29], v[90:105]
    v_exp_f32 v134, v82
    v_exp_f32 v135, v83
    v_exp_f32 v136, v84
    v_exp_f32 v137, v85
    v_pk_add_f32 v[134:135], v[134:135], 1.0 op_sel_hi:[1,0]
    v_pk_add_f32 v[136:137], v[136:137], 1.0 op_sel_hi:[1,0]
    v_mfma_f32_32x32x16_bf16 v[90:105], v[118:121], v[30:33], v[90:105]
    s_waitcnt vmcnt(0)
    ds_read_b128 v[106:109], v158
    ds_read_b128 v[110:113], v159
    ds_read_b128 v[114:117], v160
    ds_read_b128 v[118:121], v161
    v_rcp_f32 v134, v134
    v_rcp_f32 v135, v135
    v_rcp_f32 v136, v136
    v_rcp_f32 v137, v137
    v_pk_mul_f32 v[134:135], v[134:135], v[82:83]
    v_pk_mul_f32 v[136:137], v[136:137], v[84:85]
    v_cvt_pk_bf16_f32 v78, v134, v135
    v_cvt_pk_bf16_f32 v79, v136, v137
    v_mfma_f32_32x32x16_bf16 v[90:105], v[122:125], v[38:41], v[90:105]
    v_lshrrev_b32 v167, 1, v162
    v_add_u32 v167, v167, v166
    v_add_u32 v162, v162, v165
    v_lshlrev_b32 v134, 1, v163
    s_waitcnt lgkmcnt(4)
    s_and_b64 exec, s[44:45], s[50:51]
    v_pk_add_f32 v[154:155], v[154:155], v[150:151] neg_lo:[0,1] neg_hi:[0,1]
    v_sub_f32 v156, v156, v152
    v_mul_f32 v157, v154, v154
    v_fmac_f32 v157, v155, v155
    v_fmac_f32 v157, v156, v156
    v_cvt_pk_bf16_f32 v123, v155, v156
    v_cvt_pk_bf16_f32 v122, v157, v157
    v_cvt_pk_bf16_f32 v154, 1.0, v154
    ds_write2_b32 v167, v154, v123 offset0:0 offset1:1
    s_and_b64 exec, s[44:45], s[48:49]
    ds_read_b64 v[122:123], v134 offset:15104
    s_mov_b64 exec, s[44:45]
    ds_read_b64 v[124:125], v162
    s_mov_b64 exec, -1
    s_and_b64 s[40:41], s[44:45], s[50:51]
    v_exp_f32 v138, v86
    v_exp_f32 v139, v87
    v_exp_f32 v140, v88
    v_exp_f32 v141, v89
    v_pk_add_f32 v[138:139], v[138:139], 1.0 op_sel_hi:[1,0]
    v_pk_add_f32 v[140:141], v[140:141], 1.0 op_sel_hi:[1,0]
    v_rcp_f32 v138, v138
    v_rcp_f32 v139, v139
    v_rcp_f32 v140, v140
    v_rcp_f32 v141, v141
    v_pk_mul_f32 v[138:139], v[138:139], v[86:87]
    v_pk_mul_f32 v[140:141], v[140:141], v[88:89]
    v_cvt_pk_bf16_f32 v80, v138, v139
    v_cvt_pk_bf16_f32 v81, v140, v141
    s_cmp_eq_u32 s39, 0
    s_cbranch_scc1 K2_NOFLUSH

    v_mbcnt_lo_u32_b32 v155, -1, 0
    v_mbcnt_hi_u32_b32 v155, -1, v155
    v_bfe_u32 v82, v155, 2, 3
    v_add_u32 v82, s72, v82
    v_lshlrev_b32 v154, 2, v82
    ds_read_b32 v156, v154 offset:576
    v_cmp_eq_u32 s[66:67], s70, v82
    s_add_u32 s59, s32, 97
    v_mov_b32 v154, s59
    v_and_b32 v157, 3, v155
    v_lshrrev_b32 v155, 5, v155
    v_lshlrev_b32 v155, 4, v155
    ds_read_b128 v[134:137], v155 offset:1280
    ds_read_b128 v[138:141], v155 offset:1312
    s_waitcnt lgkmcnt(2)
    v_cmp_gt_u32 vcc, 98, v82
    v_cmp_gt_u32 s[64:65], s69, v156
    s_and_b64 s[64:65], s[64:65], vcc
    v_cmp_le_u32 vcc, s68, v156
    s_and_b64 s[64:65], s[64:65], vcc
    s_andn2_b64 s[66:67], s[66:67], vcc
    v_cndmask_b32 v82, v82, v154, s[66:67]
    s_or_b64 s[64:65], s[64:65], s[66:67]
    v_mad_u32_u24 v154, v82, s63, v155
    v_lshl_add_u32 v154, v157, 2, v154
    v_add_u32 v154, 57984, v154
    s_and_b64 s[66:67], s[64:65], s[52:53]
    s_and_b64 s[64:65], s[64:65], s[54:55]

    s_mov_b64 exec, s[66:67]
    ds_read_b128 v[82:85], v154 offset:0
    ds_read_b128 v[86:89], v154 offset:32
    s_mov_b64 exec, -1
    s_waitcnt lgkmcnt(2)

    v_pk_mul_f32 v[156:157], v[42:43], v[134:135]
    v_pk_fma_f32 v[156:157], v[44:45], v[136:137], v[156:157]
    v_pk_fma_f32 v[156:157], v[46:47], v[138:139], v[156:157]
    v_pk_fma_f32 v[156:157], v[48:49], v[140:141], v[156:157]
    s_waitcnt lgkmcnt(0)
    v_pk_add_f32 v[82:83], v[82:83], v[42:43]
    v_pk_add_f32 v[84:85], v[84:85], v[44:45]
    v_pk_add_f32 v[86:87], v[86:87], v[46:47]
    v_pk_add_f32 v[88:89], v[88:89], v[48:49]
    s_mov_b64 exec, s[66:67]
    ds_write_b128 v154, v[82:85] offset:0
    ds_write_b128 v154, v[86:89] offset:32
    s_mov_b64 exec, -1

    ds_read_b128 v[134:137], v155 offset:1344
    ds_read_b128 v[138:141], v155 offset:1376

    s_mov_b64 exec, s[66:67]
    ds_read_b128 v[82:85], v154 offset:64
    ds_read_b128 v[86:89], v154 offset:96
    s_mov_b64 exec, -1
    s_waitcnt lgkmcnt(2)

    v_pk_fma_f32 v[156:157], v[50:51], v[134:135], v[156:157]
    v_pk_fma_f32 v[156:157], v[52:53], v[136:137], v[156:157]
    v_pk_fma_f32 v[156:157], v[54:55], v[138:139], v[156:157]
    v_pk_fma_f32 v[156:157], v[56:57], v[140:141], v[156:157]
    s_waitcnt lgkmcnt(0)
    v_pk_add_f32 v[82:83], v[82:83], v[50:51]
    v_pk_add_f32 v[84:85], v[84:85], v[52:53]
    v_pk_add_f32 v[86:87], v[86:87], v[54:55]
    v_pk_add_f32 v[88:89], v[88:89], v[56:57]
    s_mov_b64 exec, s[66:67]
    ds_write_b128 v154, v[82:85] offset:64
    ds_write_b128 v154, v[86:89] offset:96
    s_mov_b64 exec, -1

    ds_read_b128 v[134:137], v155 offset:1408
    ds_read_b128 v[138:141], v155 offset:1440

    s_mov_b64 exec, s[66:67]
    ds_read_b128 v[82:85], v154 offset:128
    ds_read_b128 v[86:89], v154 offset:160
    s_mov_b64 exec, -1
    s_waitcnt lgkmcnt(2)

    v_pk_fma_f32 v[156:157], v[58:59], v[134:135], v[156:157]
    v_pk_fma_f32 v[156:157], v[60:61], v[136:137], v[156:157]
    v_pk_fma_f32 v[156:157], v[62:63], v[138:139], v[156:157]
    v_pk_fma_f32 v[156:157], v[64:65], v[140:141], v[156:157]
    s_waitcnt lgkmcnt(0)
    v_pk_add_f32 v[82:83], v[82:83], v[58:59]
    v_pk_add_f32 v[84:85], v[84:85], v[60:61]
    v_pk_add_f32 v[86:87], v[86:87], v[62:63]
    v_pk_add_f32 v[88:89], v[88:89], v[64:65]
    s_mov_b64 exec, s[66:67]
    ds_write_b128 v154, v[82:85] offset:128
    ds_write_b128 v154, v[86:89] offset:160
    s_mov_b64 exec, -1

    ds_read_b128 v[134:137], v155 offset:1472
    ds_read_b128 v[138:141], v155 offset:1504

    s_mov_b64 exec, s[66:67]
    ds_read_b128 v[82:85], v154 offset:192
    ds_read_b128 v[86:89], v154 offset:224
    s_mov_b64 exec, -1
    s_waitcnt lgkmcnt(2)

    v_pk_fma_f32 v[156:157], v[66:67], v[134:135], v[156:157]
    v_pk_fma_f32 v[156:157], v[68:69], v[136:137], v[156:157]
    v_pk_fma_f32 v[156:157], v[70:71], v[138:139], v[156:157]
    v_pk_fma_f32 v[156:157], v[72:73], v[140:141], v[156:157]
    s_waitcnt lgkmcnt(0)
    v_pk_add_f32 v[82:83], v[82:83], v[66:67]
    v_pk_add_f32 v[84:85], v[84:85], v[68:69]
    v_pk_add_f32 v[86:87], v[86:87], v[70:71]
    v_pk_add_f32 v[88:89], v[88:89], v[72:73]
    s_mov_b64 exec, s[66:67]
    ds_write_b128 v154, v[82:85] offset:192
    ds_write_b128 v154, v[86:89] offset:224
    s_mov_b64 exec, -1

    s_mov_b64 exec, s[64:65]
    ds_read_b32 v155, v154 offset:256
    v_add_f32 v156, v156, v157
    s_waitcnt lgkmcnt(0)
    v_add_f32 v155, v155, v156
    ds_write_b32 v154, v155 offset:256
    s_mov_b64 exec, -1

    s_mov_b32 s73, 1
    s_mov_b32 s74, 1
K2_NOFLUSH:
    s_mov_b32 s39, s42
    s_mov_b32 s72, s71
    s_cmp_eq_u32 s42, 0
    s_cbranch_scc1 K2_NOWX

    v_mbcnt_lo_u32_b32 v134, -1, 0
    v_mbcnt_hi_u32_b32 v134, -1, v134
    s_lshl_b32 s59, s37, 1
    s_add_u32 s59, s59, 44672
    v_and_b32 v135, 31, v134
    v_lshrrev_b32 v134, 5, v134
    v_lshl_add_u32 v134, v134, 3, s59
    v_mad_u32_u24 v134, v135, s62, v134
    v_add_u32 v135, 6656, v134
    ds_read2_b32 v[36:37], v134 offset0:0 offset1:1
    ds_read2_b32 v[40:41], v135 offset0:0 offset1:1

K2_NOWX:
    s_waitcnt lgkmcnt(0)
    s_cmp_eq_u32 s73, 0
    s_cbranch_scc1 K2_MZBa
    v_mfma_f32_32x32x16_bf16 v[42:57], v[74:77], v[126:129], 0
    s_mov_b32 s73, 0
    s_branch K2_MZBb
K2_MZBa:
    v_mfma_f32_32x32x16_bf16 v[42:57], v[74:77], v[126:129], v[42:57]
K2_MZBb:
    s_mov_b32 m0, s43
    s_nop 0
    buffer_load_dwordx4 v[142:143], s[16:19], 0 idxen offen lds
    s_add_u32 m0, s43, 1024
    s_nop 0
    buffer_load_dwordx4 v[144:145], s[16:19], 0 idxen offen lds
    s_add_u32 m0, s43, 2048
    s_nop 0
    buffer_load_dwordx4 v[146:147], s[16:19], 0 idxen offen lds
    s_add_u32 m0, s43, 3072
    s_nop 0
    buffer_load_dwordx4 v[148:149], s[16:19], 0 idxen offen lds
    s_mov_b64 exec, s[50:51]
    buffer_load_dwordx3 v[150:152], v153, s[24:27], 0 idxen
    s_mov_b64 exec, -1
    v_exp_f32 v134, v90
    v_exp_f32 v135, v91
    v_exp_f32 v136, v92
    v_exp_f32 v137, v93
    v_pk_add_f32 v[134:135], v[134:135], 1.0 op_sel_hi:[1,0]
    v_pk_add_f32 v[136:137], v[136:137], 1.0 op_sel_hi:[1,0]
    v_mfma_f32_32x32x16_bf16 v[42:57], v[78:81], v[130:133], v[42:57]
    ds_read_u16 v142, v164 offset:1536
    ds_read_u16 v144, v164 offset:1568
    ds_read_u16 v146, v164 offset:1600
    ds_read_u16 v148, v164 offset:1632
    ds_read_u16 v153, v163 offset:1664
    v_add_u32 v164, 128, v164
    ds_read_u16 v162, v163 offset:1538
    v_add_u32 v163, 128, v163
    v_rcp_f32 v134, v134
    v_rcp_f32 v135, v135
    v_rcp_f32 v136, v136
    v_rcp_f32 v137, v137
    v_pk_mul_f32 v[134:135], v[134:135], v[90:91]
    v_pk_mul_f32 v[136:137], v[136:137], v[92:93]
    v_cvt_pk_bf16_f32 v90, v134, v135
    v_cvt_pk_bf16_f32 v91, v136, v137
    v_mfma_f32_32x32x16_bf16 v[74:89], v[122:125], v[34:37], 0
    v_exp_f32 v138, v94
    v_exp_f32 v139, v95
    v_exp_f32 v140, v96
    v_exp_f32 v141, v97
    v_pk_add_f32 v[138:139], v[138:139], 1.0 op_sel_hi:[1,0]
    v_pk_add_f32 v[140:141], v[140:141], 1.0 op_sel_hi:[1,0]
    v_mfma_f32_32x32x16_bf16 v[74:89], v[106:109], v[2:5], v[74:89]
    v_rcp_f32 v138, v138
    v_rcp_f32 v139, v139
    v_rcp_f32 v140, v140
    v_rcp_f32 v141, v141
    v_pk_mul_f32 v[138:139], v[138:139], v[94:95]
    v_pk_mul_f32 v[140:141], v[140:141], v[96:97]
    v_cvt_pk_bf16_f32 v92, v138, v139
    v_cvt_pk_bf16_f32 v93, v140, v141
    v_mfma_f32_32x32x16_bf16 v[74:89], v[110:113], v[6:9], v[74:89]
    v_exp_f32 v134, v98
    v_exp_f32 v135, v99
    v_exp_f32 v136, v100
    v_exp_f32 v137, v101
    v_pk_add_f32 v[134:135], v[134:135], 1.0 op_sel_hi:[1,0]
    v_pk_add_f32 v[136:137], v[136:137], 1.0 op_sel_hi:[1,0]
    v_mfma_f32_32x32x16_bf16 v[74:89], v[114:117], v[10:13], v[74:89]
    v_rcp_f32 v134, v134
    v_rcp_f32 v135, v135
    v_rcp_f32 v136, v136
    v_rcp_f32 v137, v137
    v_pk_mul_f32 v[134:135], v[134:135], v[98:99]
    v_pk_mul_f32 v[136:137], v[136:137], v[100:101]
    v_cvt_pk_bf16_f32 v94, v134, v135
    v_cvt_pk_bf16_f32 v95, v136, v137
    v_mfma_f32_32x32x16_bf16 v[74:89], v[118:121], v[14:17], v[74:89]
    v_exp_f32 v138, v102
    v_exp_f32 v139, v103
    v_exp_f32 v140, v104
    v_exp_f32 v141, v105
    v_pk_add_f32 v[138:139], v[138:139], 1.0 op_sel_hi:[1,0]
    v_pk_add_f32 v[140:141], v[140:141], 1.0 op_sel_hi:[1,0]
    v_rcp_f32 v138, v138
    v_rcp_f32 v139, v139
    v_rcp_f32 v140, v140
    v_rcp_f32 v141, v141
    v_pk_mul_f32 v[138:139], v[138:139], v[102:103]
    v_pk_mul_f32 v[140:141], v[140:141], v[104:105]
    v_cvt_pk_bf16_f32 v96, v138, v139
    v_cvt_pk_bf16_f32 v97, v140, v141
    s_add_u32 s35, s35, 1
    s_cmp_lt_u32 s35, s36
    s_cbranch_scc1 K2_LOOP

    s_cmp_eq_u32 s74, 0
    s_cbranch_scc1 K2_MZCa
    v_mfma_f32_32x32x16_bf16 v[58:73], v[90:93], v[126:129], 0
    s_mov_b32 s74, 0
    s_branch K2_MZCb
K2_MZCa:
    v_mfma_f32_32x32x16_bf16 v[58:73], v[90:93], v[126:129], v[58:73]
K2_MZCb:
    v_mfma_f32_32x32x16_bf16 v[58:73], v[94:97], v[130:133], v[58:73]
    s_nop 7
    s_nop 3
    v_mbcnt_lo_u32_b32 v155, -1, 0
    v_mbcnt_hi_u32_b32 v155, -1, v155
    v_bfe_u32 v82, v155, 2, 3
    v_add_u32 v82, s37, v82
    v_lshlrev_b32 v154, 2, v82
    ds_read_b32 v156, v154 offset:576
    v_cmp_eq_u32 s[66:67], s70, v82
    s_add_u32 s59, s32, 97
    v_mov_b32 v154, s59
    v_and_b32 v157, 3, v155
    v_lshrrev_b32 v155, 5, v155
    v_lshlrev_b32 v155, 4, v155
    ds_read_b128 v[134:137], v155 offset:1280
    ds_read_b128 v[138:141], v155 offset:1312
    s_waitcnt lgkmcnt(2)
    v_cmp_gt_u32 vcc, 98, v82
    v_cmp_gt_u32 s[64:65], s69, v156
    s_and_b64 s[64:65], s[64:65], vcc
    v_cmp_le_u32 vcc, s68, v156
    s_and_b64 s[64:65], s[64:65], vcc
    s_andn2_b64 s[66:67], s[66:67], vcc
    v_cndmask_b32 v82, v82, v154, s[66:67]
    s_or_b64 s[64:65], s[64:65], s[66:67]
    v_mad_u32_u24 v154, v82, s63, v155
    v_lshl_add_u32 v154, v157, 2, v154
    v_add_u32 v154, 57984, v154
    s_and_b64 s[66:67], s[64:65], s[52:53]
    s_and_b64 s[64:65], s[64:65], s[54:55]

    s_mov_b64 exec, s[66:67]
    ds_read_b128 v[82:85], v154 offset:0
    ds_read_b128 v[86:89], v154 offset:32
    s_mov_b64 exec, -1
    s_waitcnt lgkmcnt(2)

    v_pk_mul_f32 v[156:157], v[42:43], v[134:135]
    v_pk_fma_f32 v[156:157], v[44:45], v[136:137], v[156:157]
    v_pk_fma_f32 v[156:157], v[46:47], v[138:139], v[156:157]
    v_pk_fma_f32 v[156:157], v[48:49], v[140:141], v[156:157]
    s_waitcnt lgkmcnt(0)
    v_pk_add_f32 v[82:83], v[82:83], v[42:43]
    v_pk_add_f32 v[84:85], v[84:85], v[44:45]
    v_pk_add_f32 v[86:87], v[86:87], v[46:47]
    v_pk_add_f32 v[88:89], v[88:89], v[48:49]
    s_mov_b64 exec, s[66:67]
    ds_write_b128 v154, v[82:85] offset:0
    ds_write_b128 v154, v[86:89] offset:32
    s_mov_b64 exec, -1

    ds_read_b128 v[134:137], v155 offset:1344
    ds_read_b128 v[138:141], v155 offset:1376

    s_mov_b64 exec, s[66:67]
    ds_read_b128 v[82:85], v154 offset:64
    ds_read_b128 v[86:89], v154 offset:96
    s_mov_b64 exec, -1
    s_waitcnt lgkmcnt(2)

    v_pk_fma_f32 v[156:157], v[50:51], v[134:135], v[156:157]
    v_pk_fma_f32 v[156:157], v[52:53], v[136:137], v[156:157]
    v_pk_fma_f32 v[156:157], v[54:55], v[138:139], v[156:157]
    v_pk_fma_f32 v[156:157], v[56:57], v[140:141], v[156:157]
    s_waitcnt lgkmcnt(0)
    v_pk_add_f32 v[82:83], v[82:83], v[50:51]
    v_pk_add_f32 v[84:85], v[84:85], v[52:53]
    v_pk_add_f32 v[86:87], v[86:87], v[54:55]
    v_pk_add_f32 v[88:89], v[88:89], v[56:57]
    s_mov_b64 exec, s[66:67]
    ds_write_b128 v154, v[82:85] offset:64
    ds_write_b128 v154, v[86:89] offset:96
    s_mov_b64 exec, -1

    ds_read_b128 v[134:137], v155 offset:1408
    ds_read_b128 v[138:141], v155 offset:1440

    s_mov_b64 exec, s[66:67]
    ds_read_b128 v[82:85], v154 offset:128
    ds_read_b128 v[86:89], v154 offset:160
    s_mov_b64 exec, -1
    s_waitcnt lgkmcnt(2)

    v_pk_fma_f32 v[156:157], v[58:59], v[134:135], v[156:157]
    v_pk_fma_f32 v[156:157], v[60:61], v[136:137], v[156:157]
    v_pk_fma_f32 v[156:157], v[62:63], v[138:139], v[156:157]
    v_pk_fma_f32 v[156:157], v[64:65], v[140:141], v[156:157]
    s_waitcnt lgkmcnt(0)
    v_pk_add_f32 v[82:83], v[82:83], v[58:59]
    v_pk_add_f32 v[84:85], v[84:85], v[60:61]
    v_pk_add_f32 v[86:87], v[86:87], v[62:63]
    v_pk_add_f32 v[88:89], v[88:89], v[64:65]
    s_mov_b64 exec, s[66:67]
    ds_write_b128 v154, v[82:85] offset:128
    ds_write_b128 v154, v[86:89] offset:160
    s_mov_b64 exec, -1

    ds_read_b128 v[134:137], v155 offset:1472
    ds_read_b128 v[138:141], v155 offset:1504

    s_mov_b64 exec, s[66:67]
    ds_read_b128 v[82:85], v154 offset:192
    ds_read_b128 v[86:89], v154 offset:224
    s_mov_b64 exec, -1
    s_waitcnt lgkmcnt(2)

    v_pk_fma_f32 v[156:157], v[66:67], v[134:135], v[156:157]
    v_pk_fma_f32 v[156:157], v[68:69], v[136:137], v[156:157]
    v_pk_fma_f32 v[156:157], v[70:71], v[138:139], v[156:157]
    v_pk_fma_f32 v[156:157], v[72:73], v[140:141], v[156:157]
    s_waitcnt lgkmcnt(0)
    v_pk_add_f32 v[82:83], v[82:83], v[66:67]
    v_pk_add_f32 v[84:85], v[84:85], v[68:69]
    v_pk_add_f32 v[86:87], v[86:87], v[70:71]
    v_pk_add_f32 v[88:89], v[88:89], v[72:73]
    s_mov_b64 exec, s[66:67]
    ds_write_b128 v154, v[82:85] offset:192
    ds_write_b128 v154, v[86:89] offset:224
    s_mov_b64 exec, -1

    s_mov_b64 exec, s[64:65]
    ds_read_b32 v155, v154 offset:256
    v_add_f32 v156, v156, v157
    s_waitcnt lgkmcnt(0)
    v_add_f32 v155, v155, v156
    ds_write_b32 v154, v155 offset:256
    s_mov_b64 exec, -1

K2_MAINDONE:
    s_waitcnt vmcnt(0) lgkmcnt(0)

    v_mbcnt_lo_u32_b32 v140, -1, 0
    v_mbcnt_hi_u32_b32 v140, -1, v140
    s_lshl_b32 s59, s32, 6
    v_add_u32 v141, s59, v140
    s_add_u32 s56, s56, s57
    s_cmp_lt_u32 s56, s58
    s_cbranch_scc0 K2_EPI
    s_barrier

    v_lshlrev_b32 v74, 2, v140
    ds_read2_b32 v[76:77], v74 offset0:132 offset1:133
    s_waitcnt lgkmcnt(0)
    v_cmp_lt_u32 vcc, v76, v77
    v_cmp_ne_u32 s[64:65], 0, v76
    s_and_b64 vcc, vcc, s[64:65]
    s_and_b32 s64, vcc_lo, 2047
    s_cmp_eq_u32 s64, 2047
    s_cbranch_scc0 K2_MSLOWA
    s_cmp_eq_u32 s32, 0
    s_cbranch_scc1 K2_MERGEDA
    s_mul_i32 s64, s70, 288
    s_add_u32 s64, s64, 57984
    s_mul_i32 s65, s32, 288
    s_add_u32 s65, s65, 85920
    v_add_u32 v75, s64, v74
    v_add_u32 v76, s65, v74
    v_mov_b32 v77, 0
    ds_read_b32 v78, v75
    ds_read_b32 v79, v76
    s_mov_b64 exec, 0xff
    ds_read_b32 v80, v75 offset:256
    ds_read_b32 v81, v76 offset:256
    s_mov_b64 exec, -1
    s_waitcnt lgkmcnt(0)
    v_add_f32 v78, v78, v79
    v_add_f32 v80, v80, v81
    ds_write_b32 v75, v78
    ds_write_b32 v76, v77
    s_mov_b64 exec, 0xff
    ds_write_b32 v75, v80 offset:256
    ds_write_b32 v76, v77 offset:256
    s_mov_b64 exec, -1
    s_waitcnt lgkmcnt(0)
    s_branch K2_MERGEDA
K2_MSLOWA:
    s_cmp_gt_u32 s32, 1
    s_cbranch_scc1 K2_MERGEDA
    v_cmp_gt_u32 vcc, 72, v141
    s_mov_b64 exec, vcc
    v_mov_b32 v74, 528
    ds_read_b128 v[80:83], v74
    ds_read_b128 v[84:87], v74 offset:16
    ds_read_b128 v[88:91], v74 offset:32
    v_lshlrev_b32 v75, 2, v141
    v_add_u32 v75, 57984, v75
    v_mov_b32 v76, 0

    ds_read_b32 v93, v75 offset:28224
    ds_read_b32 v94, v75 offset:28512
    ds_read_b32 v95, v75 offset:28800
    ds_read_b32 v96, v75 offset:29088
    ds_read_b32 v97, v75 offset:29376
    ds_read_b32 v98, v75 offset:29664
    ds_read_b32 v99, v75 offset:29952
    ds_read_b32 v100, v75 offset:30240
    ds_read_b32 v101, v75 offset:30528
    ds_read_b32 v102, v75 offset:30816
    ds_read_b32 v103, v75 offset:31104
    s_waitcnt lgkmcnt(0)
    v_max_u32 v77, 1, v81
    v_mul_u32_u24 v77, 288, v77
    v_add_u32 v77, v77, v75
    v_subrev_u32 v77, 288, v77
    ds_read_b32 v78, v77
    ds_write_b32 v75, v76 offset:28224
    s_waitcnt lgkmcnt(0)
    v_add_f32 v78, v78, v93
    ds_write_b32 v77, v78

    v_max_u32 v77, 1, v82
    v_mul_u32_u24 v77, 288, v77
    v_add_u32 v77, v77, v75
    v_subrev_u32 v77, 288, v77
    ds_read_b32 v78, v77
    ds_write_b32 v75, v76 offset:28512
    s_waitcnt lgkmcnt(0)
    v_add_f32 v78, v78, v94
    ds_write_b32 v77, v78

    v_max_u32 v77, 1, v83
    v_mul_u32_u24 v77, 288, v77
    v_add_u32 v77, v77, v75
    v_subrev_u32 v77, 288, v77
    ds_read_b32 v78, v77
    ds_write_b32 v75, v76 offset:28800
    s_waitcnt lgkmcnt(0)
    v_add_f32 v78, v78, v95
    ds_write_b32 v77, v78

    v_max_u32 v77, 1, v84
    v_mul_u32_u24 v77, 288, v77
    v_add_u32 v77, v77, v75
    v_subrev_u32 v77, 288, v77
    ds_read_b32 v78, v77
    ds_write_b32 v75, v76 offset:29088
    s_waitcnt lgkmcnt(0)
    v_add_f32 v78, v78, v96
    ds_write_b32 v77, v78

    v_max_u32 v77, 1, v85
    v_mul_u32_u24 v77, 288, v77
    v_add_u32 v77, v77, v75
    v_subrev_u32 v77, 288, v77
    ds_read_b32 v78, v77
    ds_write_b32 v75, v76 offset:29376
    s_waitcnt lgkmcnt(0)
    v_add_f32 v78, v78, v97
    ds_write_b32 v77, v78

    v_max_u32 v77, 1, v86
    v_mul_u32_u24 v77, 288, v77
    v_add_u32 v77, v77, v75
    v_subrev_u32 v77, 288, v77
    ds_read_b32 v78, v77
    ds_write_b32 v75, v76 offset:29664
    s_waitcnt lgkmcnt(0)
    v_add_f32 v78, v78, v98
    ds_write_b32 v77, v78

    v_max_u32 v77, 1, v87
    v_mul_u32_u24 v77, 288, v77
    v_add_u32 v77, v77, v75
    v_subrev_u32 v77, 288, v77
    ds_read_b32 v78, v77
    ds_write_b32 v75, v76 offset:29952
    s_waitcnt lgkmcnt(0)
    v_add_f32 v78, v78, v99
    ds_write_b32 v77, v78

    v_max_u32 v77, 1, v88
    v_mul_u32_u24 v77, 288, v77
    v_add_u32 v77, v77, v75
    v_subrev_u32 v77, 288, v77
    ds_read_b32 v78, v77
    ds_write_b32 v75, v76 offset:30240
    s_waitcnt lgkmcnt(0)
    v_add_f32 v78, v78, v100
    ds_write_b32 v77, v78

    v_max_u32 v77, 1, v89
    v_mul_u32_u24 v77, 288, v77
    v_add_u32 v77, v77, v75
    v_subrev_u32 v77, 288, v77
    ds_read_b32 v78, v77
    ds_write_b32 v75, v76 offset:30528
    s_waitcnt lgkmcnt(0)
    v_add_f32 v78, v78, v101
    ds_write_b32 v77, v78

    v_max_u32 v77, 1, v90
    v_mul_u32_u24 v77, 288, v77
    v_add_u32 v77, v77, v75
    v_subrev_u32 v77, 288, v77
    ds_read_b32 v78, v77
    ds_write_b32 v75, v76 offset:30816
    s_waitcnt lgkmcnt(0)
    v_add_f32 v78, v78, v102
    ds_write_b32 v77, v78

    v_max_u32 v77, 1, v91
    v_mul_u32_u24 v77, 288, v77
    v_add_u32 v77, v77, v75
    v_subrev_u32 v77, 288, v77
    ds_read_b32 v78, v77
    ds_write_b32 v75, v76 offset:31104
    s_waitcnt lgkmcnt(0)
    v_add_f32 v78, v78, v103
    ds_write_b32 v77, v78

    s_waitcnt lgkmcnt(0)
    s_mov_b64 exec, -1
K2_MERGEDA:

    s_barrier
    s_branch K2_ROUND
K2_EPI:
    s_mov_b32 s24, s10
    s_mov_b32 s25, s11
    s_mov_b32 s26, 3200000
    s_mov_b32 s27, 0x00020000

    s_cmp_gt_u32 s32, 7
    s_cbranch_scc1 K2_EPI_POS
    s_lshr_b32 s59, s32, 1
    s_lshl_b32 s59, s59, 5
    s_add_u32 s59, s59, s33
    v_lshrrev_b32 v142, 3, v140
    v_add_u32 v142, s59, v142
    v_add_u32 v144, 8, v142
    v_add_u32 v146, 16, v142
    v_add_u32 v148, 24, v142

    s_mov_b32 m0, s43
    s_nop 0
    buffer_load_dwordx4 v[142:143], s[16:19], 0 idxen offen lds
    s_add_u32 m0, s43, 1024
    s_nop 0
    buffer_load_dwordx4 v[144:145], s[16:19], 0 idxen offen lds
    s_add_u32 m0, s43, 2048
    s_nop 0
    buffer_load_dwordx4 v[146:147], s[16:19], 0 idxen offen lds
    s_add_u32 m0, s43, 3072
    s_nop 0
    buffer_load_dwordx4 v[148:149], s[16:19], 0 idxen offen lds
    s_lshr_b32 s59, s32, 1
    s_and_b32 s60, s32, 1
    v_lshlrev_b32 v44, 4, v140
    s_lshl_b32 s14, s60, 13
    s_add_u32 s14, s14, 17842176
    s_add_u32 s61, s14, 4096

    buffer_load_dwordx4 v[2:5], v44, s[20:23], s14 offen offset:0
    buffer_load_dwordx4 v[6:9], v44, s[20:23], s14 offen offset:1024
    buffer_load_dwordx4 v[10:13], v44, s[20:23], s14 offen offset:2048
    buffer_load_dwordx4 v[14:17], v44, s[20:23], s14 offen offset:3072
    buffer_load_dwordx4 v[18:21], v44, s[20:23], s61 offen offset:0
    buffer_load_dwordx4 v[22:25], v44, s[20:23], s61 offen offset:1024
    buffer_load_dwordx4 v[26:29], v44, s[20:23], s61 offen offset:2048
    buffer_load_dwordx4 v[30:33], v44, s[20:23], s61 offen offset:3072
    s_mov_b32 s24, s10
    s_mov_b32 s25, s11
    s_mov_b32 s26, 3200000
    s_mov_b32 s27, 0x00020000
    v_and_b32 v48, 31, v140
    v_lshrrev_b32 v49, 5, v140
    s_lshl_b32 s61, s59, 5
    v_add_u32 v50, s61, v48
    v_min_u32 v53, 108, v50
    v_mul_u32_u24 v53, 288, v53
    v_lshl_add_u32 v53, v49, 7, v53
    v_add_u32 v53, 57984, v53
    v_bfe_u32 v54, v48, 1, 3
    s_lshl_b32 s61, s60, 2
    v_xor_b32 v54, s61, v54
    v_lshlrev_b32 v54, 4, v54
    v_lshl_add_u32 v54, v48, 7, v54
    v_lshl_add_u32 v54, v49, 3, v54
    v_add_u32 v54, s43, v54
    v_xor_b32 v55, 16, v54
    v_xor_b32 v59, 32, v54
    v_xor_b32 v60, 48, v54
    v_add_u32 v61, s33, v50
    v_lshlrev_b32 v61, 7, v61
    v_lshl_add_u32 v61, v49, 3, v61
    s_lshl_b32 s61, s60, 6
    v_add_u32 v61, s61, v61
    s_barrier

    v_lshlrev_b32 v74, 2, v140
    ds_read2_b32 v[76:77], v74 offset0:132 offset1:133
    s_waitcnt lgkmcnt(0)
    v_cmp_lt_u32 vcc, v76, v77
    v_cmp_ne_u32 s[64:65], 0, v76
    s_and_b64 vcc, vcc, s[64:65]
    s_and_b32 s64, vcc_lo, 2047
    s_cmp_eq_u32 s64, 2047
    s_cbranch_scc0 K2_MSLOWB
    s_cmp_eq_u32 s32, 0
    s_cbranch_scc1 K2_MERGEDB
    s_mul_i32 s64, s70, 288
    s_add_u32 s64, s64, 57984
    s_mul_i32 s65, s32, 288
    s_add_u32 s65, s65, 85920
    v_add_u32 v75, s64, v74
    v_add_u32 v76, s65, v74
    v_mov_b32 v77, 0
    ds_read_b32 v78, v75
    ds_read_b32 v79, v76
    s_mov_b64 exec, 0xff
    ds_read_b32 v80, v75 offset:256
    ds_read_b32 v81, v76 offset:256
    s_mov_b64 exec, -1
    s_waitcnt lgkmcnt(0)
    v_add_f32 v78, v78, v79
    v_add_f32 v80, v80, v81
    ds_write_b32 v75, v78
    ds_write_b32 v76, v77
    s_mov_b64 exec, 0xff
    ds_write_b32 v75, v80 offset:256
    ds_write_b32 v76, v77 offset:256
    s_mov_b64 exec, -1
    s_waitcnt lgkmcnt(0)
    s_branch K2_MERGEDB
K2_MSLOWB:
    s_cmp_gt_u32 s32, 1
    s_cbranch_scc1 K2_MERGEDB
    v_cmp_gt_u32 vcc, 72, v141
    s_mov_b64 exec, vcc
    v_mov_b32 v74, 528
    ds_read_b128 v[80:83], v74
    ds_read_b128 v[84:87], v74 offset:16
    ds_read_b128 v[88:91], v74 offset:32
    v_lshlrev_b32 v75, 2, v141
    v_add_u32 v75, 57984, v75
    v_mov_b32 v76, 0

    ds_read_b32 v93, v75 offset:28224
    ds_read_b32 v94, v75 offset:28512
    ds_read_b32 v95, v75 offset:28800
    ds_read_b32 v96, v75 offset:29088
    ds_read_b32 v97, v75 offset:29376
    ds_read_b32 v98, v75 offset:29664
    ds_read_b32 v99, v75 offset:29952
    ds_read_b32 v100, v75 offset:30240
    ds_read_b32 v101, v75 offset:30528
    ds_read_b32 v102, v75 offset:30816
    ds_read_b32 v103, v75 offset:31104
    s_waitcnt lgkmcnt(0)
    v_max_u32 v77, 1, v81
    v_mul_u32_u24 v77, 288, v77
    v_add_u32 v77, v77, v75
    v_subrev_u32 v77, 288, v77
    ds_read_b32 v78, v77
    ds_write_b32 v75, v76 offset:28224
    s_waitcnt lgkmcnt(0)
    v_add_f32 v78, v78, v93
    ds_write_b32 v77, v78

    v_max_u32 v77, 1, v82
    v_mul_u32_u24 v77, 288, v77
    v_add_u32 v77, v77, v75
    v_subrev_u32 v77, 288, v77
    ds_read_b32 v78, v77
    ds_write_b32 v75, v76 offset:28512
    s_waitcnt lgkmcnt(0)
    v_add_f32 v78, v78, v94
    ds_write_b32 v77, v78

    v_max_u32 v77, 1, v83
    v_mul_u32_u24 v77, 288, v77
    v_add_u32 v77, v77, v75
    v_subrev_u32 v77, 288, v77
    ds_read_b32 v78, v77
    ds_write_b32 v75, v76 offset:28800
    s_waitcnt lgkmcnt(0)
    v_add_f32 v78, v78, v95
    ds_write_b32 v77, v78

    v_max_u32 v77, 1, v84
    v_mul_u32_u24 v77, 288, v77
    v_add_u32 v77, v77, v75
    v_subrev_u32 v77, 288, v77
    ds_read_b32 v78, v77
    ds_write_b32 v75, v76 offset:29088
    s_waitcnt lgkmcnt(0)
    v_add_f32 v78, v78, v96
    ds_write_b32 v77, v78

    v_max_u32 v77, 1, v85
    v_mul_u32_u24 v77, 288, v77
    v_add_u32 v77, v77, v75
    v_subrev_u32 v77, 288, v77
    ds_read_b32 v78, v77
    ds_write_b32 v75, v76 offset:29376
    s_waitcnt lgkmcnt(0)
    v_add_f32 v78, v78, v97
    ds_write_b32 v77, v78

    v_max_u32 v77, 1, v86
    v_mul_u32_u24 v77, 288, v77
    v_add_u32 v77, v77, v75
    v_subrev_u32 v77, 288, v77
    ds_read_b32 v78, v77
    ds_write_b32 v75, v76 offset:29664
    s_waitcnt lgkmcnt(0)
    v_add_f32 v78, v78, v98
    ds_write_b32 v77, v78

    v_max_u32 v77, 1, v87
    v_mul_u32_u24 v77, 288, v77
    v_add_u32 v77, v77, v75
    v_subrev_u32 v77, 288, v77
    ds_read_b32 v78, v77
    ds_write_b32 v75, v76 offset:29952
    s_waitcnt lgkmcnt(0)
    v_add_f32 v78, v78, v99
    ds_write_b32 v77, v78

    v_max_u32 v77, 1, v88
    v_mul_u32_u24 v77, 288, v77
    v_add_u32 v77, v77, v75
    v_subrev_u32 v77, 288, v77
    ds_read_b32 v78, v77
    ds_write_b32 v75, v76 offset:30240
    s_waitcnt lgkmcnt(0)
    v_add_f32 v78, v78, v100
    ds_write_b32 v77, v78

    v_max_u32 v77, 1, v89
    v_mul_u32_u24 v77, 288, v77
    v_add_u32 v77, v77, v75
    v_subrev_u32 v77, 288, v77
    ds_read_b32 v78, v77
    ds_write_b32 v75, v76 offset:30528
    s_waitcnt lgkmcnt(0)
    v_add_f32 v78, v78, v101
    ds_write_b32 v77, v78

    v_max_u32 v77, 1, v90
    v_mul_u32_u24 v77, 288, v77
    v_add_u32 v77, v77, v75
    v_subrev_u32 v77, 288, v77
    ds_read_b32 v78, v77
    ds_write_b32 v75, v76 offset:30816
    s_waitcnt lgkmcnt(0)
    v_add_f32 v78, v78, v102
    ds_write_b32 v77, v78

    v_max_u32 v77, 1, v91
    v_mul_u32_u24 v77, 288, v77
    v_add_u32 v77, v77, v75
    v_subrev_u32 v77, 288, v77
    ds_read_b32 v78, v77
    ds_write_b32 v75, v76 offset:31104
    s_waitcnt lgkmcnt(0)
    v_add_f32 v78, v78, v103
    ds_write_b32 v77, v78

    s_waitcnt lgkmcnt(0)
    s_mov_b64 exec, -1
K2_MERGEDB:

    s_barrier
    ds_read_b128 v[74:77], v53 offset:0
    ds_read_b128 v[78:81], v53 offset:16
    ds_read_b128 v[82:85], v53 offset:32
    ds_read_b128 v[86:89], v53 offset:48
    ds_read_b128 v[90:93], v53 offset:64
    ds_read_b128 v[94:97], v53 offset:80
    ds_read_b128 v[98:101], v53 offset:96
    ds_read_b128 v[102:105], v53 offset:112
    s_waitcnt vmcnt(8)
    ds_read_b128 v[106:109], v158
    ds_read_b128 v[110:113], v159
    ds_read_b128 v[114:117], v160
    ds_read_b128 v[118:121], v161
    ds_read_b64 v[34:35], v54
    ds_read_b64 v[36:37], v55
    ds_read_b64 v[38:39], v59
    ds_read_b64 v[40:41], v60
    s_waitcnt lgkmcnt(8)

    s_mov_b32 s64, 0xbf317218
    s_mov_b32 s65, 0xbf317218
    v_pk_mul_f32 v[74:75], v[74:75], s[64:65]
    v_cvt_pk_bf16_f32 v122, v74, v75
    v_pk_mul_f32 v[76:77], v[76:77], s[64:65]
    v_cvt_pk_bf16_f32 v123, v76, v77
    v_pk_mul_f32 v[78:79], v[78:79], s[64:65]
    v_cvt_pk_bf16_f32 v124, v78, v79
    v_pk_mul_f32 v[80:81], v[80:81], s[64:65]
    v_cvt_pk_bf16_f32 v125, v80, v81
    v_pk_mul_f32 v[82:83], v[82:83], s[64:65]
    v_cvt_pk_bf16_f32 v126, v82, v83
    v_pk_mul_f32 v[84:85], v[84:85], s[64:65]
    v_cvt_pk_bf16_f32 v127, v84, v85
    v_pk_mul_f32 v[86:87], v[86:87], s[64:65]
    v_cvt_pk_bf16_f32 v128, v86, v87
    v_pk_mul_f32 v[88:89], v[88:89], s[64:65]
    v_cvt_pk_bf16_f32 v129, v88, v89
    v_pk_mul_f32 v[90:91], v[90:91], s[64:65]
    v_cvt_pk_bf16_f32 v130, v90, v91
    v_pk_mul_f32 v[92:93], v[92:93], s[64:65]
    v_cvt_pk_bf16_f32 v131, v92, v93
    v_pk_mul_f32 v[94:95], v[94:95], s[64:65]
    v_cvt_pk_bf16_f32 v132, v94, v95
    v_pk_mul_f32 v[96:97], v[96:97], s[64:65]
    v_cvt_pk_bf16_f32 v133, v96, v97
    v_pk_mul_f32 v[98:99], v[98:99], s[64:65]
    v_cvt_pk_bf16_f32 v134, v98, v99
    v_pk_mul_f32 v[100:101], v[100:101], s[64:65]
    v_cvt_pk_bf16_f32 v135, v100, v101
    v_pk_mul_f32 v[102:103], v[102:103], s[64:65]
    v_cvt_pk_bf16_f32 v136, v102, v103
    v_pk_mul_f32 v[104:105], v[104:105], s[64:65]
    v_cvt_pk_bf16_f32 v137, v104, v105
    s_waitcnt vmcnt(0) lgkmcnt(0)
    v_mfma_f32_32x32x16_bf16 v[74:89], v[2:5], v[106:109], 0
    v_mfma_f32_32x32x16_bf16 v[74:89], v[6:9], v[110:113], v[74:89]
    v_mfma_f32_32x32x16_bf16 v[74:89], v[10:13], v[114:117], v[74:89]
    v_mfma_f32_32x32x16_bf16 v[74:89], v[14:17], v[118:121], v[74:89]
    v_mfma_f32_32x32x16_bf16 v[74:89], v[18:21], v[122:125], v[74:89]
    v_mfma_f32_32x32x16_bf16 v[74:89], v[22:25], v[126:129], v[74:89]
    v_mfma_f32_32x32x16_bf16 v[74:89], v[26:29], v[130:133], v[74:89]
    v_mfma_f32_32x32x16_bf16 v[74:89], v[30:33], v[134:137], v[74:89]
    v_cmp_gt_u32 vcc, 98, v50
    s_nop 7
    s_nop 3

    v_pk_mul_f32 v[106:107], v[74:75], s[46:47]
    v_pk_mul_f32 v[108:109], v[76:77], s[46:47]
    v_pk_mul_f32 v[110:111], v[78:79], s[46:47]
    v_pk_mul_f32 v[112:113], v[80:81], s[46:47]
    v_pk_mul_f32 v[114:115], v[82:83], s[46:47]
    v_pk_mul_f32 v[116:117], v[84:85], s[46:47]
    v_pk_mul_f32 v[118:119], v[86:87], s[46:47]
    v_pk_mul_f32 v[120:121], v[88:89], s[46:47]
    v_exp_f32 v106, v106
    v_exp_f32 v107, v107
    v_exp_f32 v108, v108
    v_exp_f32 v109, v109
    v_exp_f32 v110, v110
    v_exp_f32 v111, v111
    v_exp_f32 v112, v112
    v_exp_f32 v113, v113
    v_exp_f32 v114, v114
    v_exp_f32 v115, v115
    v_exp_f32 v116, v116
    v_exp_f32 v117, v117
    v_exp_f32 v118, v118
    v_exp_f32 v119, v119
    v_exp_f32 v120, v120
    v_exp_f32 v121, v121
    v_lshlrev_b32 v122, 16, v34
    v_and_b32 v123, 0xffff0000, v34
    v_lshlrev_b32 v124, 16, v35
    v_and_b32 v125, 0xffff0000, v35
    v_lshlrev_b32 v126, 16, v36
    v_and_b32 v127, 0xffff0000, v36
    v_lshlrev_b32 v128, 16, v37
    v_and_b32 v129, 0xffff0000, v37
    v_lshlrev_b32 v130, 16, v38
    v_and_b32 v131, 0xffff0000, v38
    v_lshlrev_b32 v132, 16, v39
    v_and_b32 v133, 0xffff0000, v39
    v_lshlrev_b32 v134, 16, v40
    v_and_b32 v135, 0xffff0000, v40
    v_lshlrev_b32 v136, 16, v41
    v_and_b32 v137, 0xffff0000, v41
    v_pk_add_f32 v[106:107], v[106:107], 1.0 op_sel_hi:[1,0]
    v_pk_add_f32 v[108:109], v[108:109], 1.0 op_sel_hi:[1,0]
    v_pk_add_f32 v[110:111], v[110:111], 1.0 op_sel_hi:[1,0]
    v_pk_add_f32 v[112:113], v[112:113], 1.0 op_sel_hi:[1,0]
    v_pk_add_f32 v[114:115], v[114:115], 1.0 op_sel_hi:[1,0]
    v_pk_add_f32 v[116:117], v[116:117], 1.0 op_sel_hi:[1,0]
    v_pk_add_f32 v[118:119], v[118:119], 1.0 op_sel_hi:[1,0]
    v_pk_add_f32 v[120:121], v[120:121], 1.0 op_sel_hi:[1,0]
    v_rcp_f32 v106, v106
    v_rcp_f32 v107, v107
    v_rcp_f32 v108, v108
    v_rcp_f32 v109, v109
    v_rcp_f32 v110, v110
    v_rcp_f32 v111, v111
    v_rcp_f32 v112, v112
    v_rcp_f32 v113, v113
    v_rcp_f32 v114, v114
    v_rcp_f32 v115, v115
    v_rcp_f32 v116, v116
    v_rcp_f32 v117, v117
    v_rcp_f32 v118, v118
    v_rcp_f32 v119, v119
    v_rcp_f32 v120, v120
    v_rcp_f32 v121, v121
    s_nop 0
    v_pk_fma_f32 v[74:75], v[74:75], v[106:107], v[122:123]
    v_pk_fma_f32 v[76:77], v[76:77], v[108:109], v[124:125]
    v_pk_fma_f32 v[78:79], v[78:79], v[110:111], v[126:127]
    v_pk_fma_f32 v[80:81], v[80:81], v[112:113], v[128:129]
    v_pk_fma_f32 v[82:83], v[82:83], v[114:115], v[130:131]
    v_pk_fma_f32 v[84:85], v[84:85], v[116:117], v[132:133]
    v_pk_fma_f32 v[86:87], v[86:87], v[118:119], v[134:135]
    v_pk_fma_f32 v[88:89], v[88:89], v[120:121], v[136:137]
    v_cvt_pk_bf16_f32 v96, v74, v75
    v_cvt_pk_bf16_f32 v97, v76, v77
    v_cvt_pk_bf16_f32 v98, v78, v79
    v_cvt_pk_bf16_f32 v99, v80, v81
    v_cvt_pk_bf16_f32 v100, v82, v83
    v_cvt_pk_bf16_f32 v101, v84, v85
    v_cvt_pk_bf16_f32 v102, v86, v87
    v_cvt_pk_bf16_f32 v103, v88, v89
    s_mov_b64 exec, vcc
    buffer_store_dwordx2 v[96:97], v61, s[24:27], 0 offen offset:0
    buffer_store_dwordx2 v[98:99], v61, s[24:27], 0 offen offset:16
    buffer_store_dwordx2 v[100:101], v61, s[24:27], 0 offen offset:32
    buffer_store_dwordx2 v[102:103], v61, s[24:27], 0 offen offset:48
    s_endpgm
K2_EPI_POS:
    v_subrev_u32 v50, 512, v141
    v_lshlrev_b32 v52, 4, v50
    v_add_u32 v51, s33, v50
    v_mul_u32_u24 v51, 6, v51
    v_min_u32 v53, 108, v50
    v_mul_u32_u24 v53, 288, v53
    v_add_u32 v53, 57984, v53
    s_add_u32 s28, s10, 3200000
    s_addc_u32 s29, s11, 0
    s_mov_b32 s30, 150000
    s_barrier

    v_lshlrev_b32 v74, 2, v140
    ds_read2_b32 v[76:77], v74 offset0:132 offset1:133
    s_waitcnt lgkmcnt(0)
    v_cmp_lt_u32 vcc, v76, v77
    v_cmp_ne_u32 s[64:65], 0, v76
    s_and_b64 vcc, vcc, s[64:65]
    s_and_b32 s64, vcc_lo, 2047
    s_cmp_eq_u32 s64, 2047
    s_cbranch_scc0 K2_MSLOWC
    s_cmp_eq_u32 s32, 0
    s_cbranch_scc1 K2_MERGEDC
    s_mul_i32 s64, s70, 288
    s_add_u32 s64, s64, 57984
    s_mul_i32 s65, s32, 288
    s_add_u32 s65, s65, 85920
    v_add_u32 v75, s64, v74
    v_add_u32 v76, s65, v74
    v_mov_b32 v77, 0
    ds_read_b32 v78, v75
    ds_read_b32 v79, v76
    s_mov_b64 exec, 0xff
    ds_read_b32 v80, v75 offset:256
    ds_read_b32 v81, v76 offset:256
    s_mov_b64 exec, -1
    s_waitcnt lgkmcnt(0)
    v_add_f32 v78, v78, v79
    v_add_f32 v80, v80, v81
    ds_write_b32 v75, v78
    ds_write_b32 v76, v77
    s_mov_b64 exec, 0xff
    ds_write_b32 v75, v80 offset:256
    ds_write_b32 v76, v77 offset:256
    s_mov_b64 exec, -1
    s_waitcnt lgkmcnt(0)
    s_branch K2_MERGEDC
K2_MSLOWC:
    s_cmp_gt_u32 s32, 1
    s_cbranch_scc1 K2_MERGEDC
    v_cmp_gt_u32 vcc, 72, v141
    s_mov_b64 exec, vcc
    v_mov_b32 v74, 528
    ds_read_b128 v[80:83], v74
    ds_read_b128 v[84:87], v74 offset:16
    ds_read_b128 v[88:91], v74 offset:32
    v_lshlrev_b32 v75, 2, v141
    v_add_u32 v75, 57984, v75
    v_mov_b32 v76, 0

    ds_read_b32 v93, v75 offset:28224
    ds_read_b32 v94, v75 offset:28512
    ds_read_b32 v95, v75 offset:28800
    ds_read_b32 v96, v75 offset:29088
    ds_read_b32 v97, v75 offset:29376
    ds_read_b32 v98, v75 offset:29664
    ds_read_b32 v99, v75 offset:29952
    ds_read_b32 v100, v75 offset:30240
    ds_read_b32 v101, v75 offset:30528
    ds_read_b32 v102, v75 offset:30816
    ds_read_b32 v103, v75 offset:31104
    s_waitcnt lgkmcnt(0)
    v_max_u32 v77, 1, v81
    v_mul_u32_u24 v77, 288, v77
    v_add_u32 v77, v77, v75
    v_subrev_u32 v77, 288, v77
    ds_read_b32 v78, v77
    ds_write_b32 v75, v76 offset:28224
    s_waitcnt lgkmcnt(0)
    v_add_f32 v78, v78, v93
    ds_write_b32 v77, v78

    v_max_u32 v77, 1, v82
    v_mul_u32_u24 v77, 288, v77
    v_add_u32 v77, v77, v75
    v_subrev_u32 v77, 288, v77
    ds_read_b32 v78, v77
    ds_write_b32 v75, v76 offset:28512
    s_waitcnt lgkmcnt(0)
    v_add_f32 v78, v78, v94
    ds_write_b32 v77, v78

    v_max_u32 v77, 1, v83
    v_mul_u32_u24 v77, 288, v77
    v_add_u32 v77, v77, v75
    v_subrev_u32 v77, 288, v77
    ds_read_b32 v78, v77
    ds_write_b32 v75, v76 offset:28800
    s_waitcnt lgkmcnt(0)
    v_add_f32 v78, v78, v95
    ds_write_b32 v77, v78

    v_max_u32 v77, 1, v84
    v_mul_u32_u24 v77, 288, v77
    v_add_u32 v77, v77, v75
    v_subrev_u32 v77, 288, v77
    ds_read_b32 v78, v77
    ds_write_b32 v75, v76 offset:29088
    s_waitcnt lgkmcnt(0)
    v_add_f32 v78, v78, v96
    ds_write_b32 v77, v78

    v_max_u32 v77, 1, v85
    v_mul_u32_u24 v77, 288, v77
    v_add_u32 v77, v77, v75
    v_subrev_u32 v77, 288, v77
    ds_read_b32 v78, v77
    ds_write_b32 v75, v76 offset:29376
    s_waitcnt lgkmcnt(0)
    v_add_f32 v78, v78, v97
    ds_write_b32 v77, v78

    v_max_u32 v77, 1, v86
    v_mul_u32_u24 v77, 288, v77
    v_add_u32 v77, v77, v75
    v_subrev_u32 v77, 288, v77
    ds_read_b32 v78, v77
    ds_write_b32 v75, v76 offset:29664
    s_waitcnt lgkmcnt(0)
    v_add_f32 v78, v78, v98
    ds_write_b32 v77, v78

    v_max_u32 v77, 1, v87
    v_mul_u32_u24 v77, 288, v77
    v_add_u32 v77, v77, v75
    v_subrev_u32 v77, 288, v77
    ds_read_b32 v78, v77
    ds_write_b32 v75, v76 offset:29952
    s_waitcnt lgkmcnt(0)
    v_add_f32 v78, v78, v99
    ds_write_b32 v77, v78

    v_max_u32 v77, 1, v88
    v_mul_u32_u24 v77, 288, v77
    v_add_u32 v77, v77, v75
    v_subrev_u32 v77, 288, v77
    ds_read_b32 v78, v77
    ds_write_b32 v75, v76 offset:30240
    s_waitcnt lgkmcnt(0)
    v_add_f32 v78, v78, v100
    ds_write_b32 v77, v78

    v_max_u32 v77, 1, v89
    v_mul_u32_u24 v77, 288, v77
    v_add_u32 v77, v77, v75
    v_subrev_u32 v77, 288, v77
    ds_read_b32 v78, v77
    ds_write_b32 v75, v76 offset:30528
    s_waitcnt lgkmcnt(0)
    v_add_f32 v78, v78, v101
    ds_write_b32 v77, v78

    v_max_u32 v77, 1, v90
    v_mul_u32_u24 v77, 288, v77
    v_add_u32 v77, v77, v75
    v_subrev_u32 v77, 288, v77
    ds_read_b32 v78, v77
    ds_write_b32 v75, v76 offset:30816
    s_waitcnt lgkmcnt(0)
    v_add_f32 v78, v78, v102
    ds_write_b32 v77, v78

    v_max_u32 v77, 1, v91
    v_mul_u32_u24 v77, 288, v77
    v_add_u32 v77, v77, v75
    v_subrev_u32 v77, 288, v77
    ds_read_b32 v78, v77
    ds_write_b32 v75, v76 offset:31104
    s_waitcnt lgkmcnt(0)
    v_add_f32 v78, v78, v103
    ds_write_b32 v77, v78

    s_waitcnt lgkmcnt(0)
    s_mov_b64 exec, -1
K2_MERGEDC:

    s_barrier
    v_cmp_gt_u32 vcc, 98, v50
    s_mov_b64 exec, vcc
    s_cbranch_execz K2_EXIT
    ds_read_b128 v[44:47], v53 offset:256
    ds_read_b128 v[56:59], v53 offset:272
    ds_read_b128 v[60:63], v52 offset:43008
    s_waitcnt lgkmcnt(0)
    v_add_f32 v45, v45, v57
    v_add_f32 v46, v46, v58
    v_add_f32 v47, v47, v59
    v_add_f32 v60, v60, v45
    v_add_f32 v61, v61, v46
    v_add_f32 v62, v62, v47
    v_cvt_pk_bf16_f32 v60, v60, v61
    v_cvt_pk_bf16_f32 v62, v62, v62
    buffer_store_short v60, v51, s[28:31], 0 offen
    buffer_store_short_d16_hi v60, v51, s[28:31], 0 offen offset:2
    buffer_store_short v62, v51, s[28:31], 0 offen offset:4

K2_EXIT:
    s_endpgm

.section .rodata,"a"
.p2align 6
.amdhsa_kernel egnn_part_kernel
  .amdhsa_next_free_vgpr 120
  .amdhsa_next_free_sgpr 64
  .amdhsa_accum_offset 120
  .amdhsa_group_segment_fixed_size 0
  .amdhsa_kernarg_size 88
  .amdhsa_user_sgpr_count 2
  .amdhsa_user_sgpr_kernarg_segment_ptr 1
  .amdhsa_system_sgpr_workgroup_id_x 1
.end_amdhsa_kernel
.p2align 6
.amdhsa_kernel egnn_main_kernel
  .amdhsa_next_free_vgpr 168
  .amdhsa_next_free_sgpr 102
  .amdhsa_accum_offset 168
  .amdhsa_group_segment_fixed_size 0
  .amdhsa_kernarg_size 88
  .amdhsa_user_sgpr_count 2
  .amdhsa_user_sgpr_kernarg_segment_ptr 1
  .amdhsa_system_sgpr_workgroup_id_x 1
.end_amdhsa_kernel
```
